```python
import torch

def _softmax(x, axis=-1):
    return torch.softmax(x, dim=axis)
def _gelu(x):
    return torch.nn.functional.gelu(x, approximate="tanh")
def _silu(x):
    return torch.nn.functional.silu(x)
def _sigmoid(x):
    return torch.sigmoid(x)
def _layernorm(x, axis=-1, eps=1e-5):
    m = x.mean(dim=axis, keepdim=True)
    v = x.var(dim=axis, keepdim=True, unbiased=False)
    return (x - m) / torch.sqrt(v + eps)
def _scatter_add(tgt, idx, src, axis=0):
    return tgt.clone().index_add_(axis, idx, src)
def _segment_sum(src, seg, n):
    out = torch.zeros((n,) + src.shape[1:], dtype=src.dtype)
    return out.index_add_(0, seg, src)
def _pad(x, pw):
    flat = tuple(v for pair in reversed(pw) for v in pair)
    return torch.nn.functional.pad(x, flat)

kernel_name = 'sequential_preLN__gqa_block_cached__dense_activation_squared_relu__decode'

def setup_inputs():

    _w = (lambda a: (lambda t: t.to(torch.bfloat16) if t.is_floating_point() else t)(torch.as_tensor(a)))
    def _A_setup():
        B, Sq, D = 4, 1, 512
        Hq, Hkv, Sk, Dh = 32, 8, 8192, 128
        assert Hq % Hkv == 0, (Hq, Hkv)
        return {
            "x": _w((lambda *s: torch.randn(*s, dtype=torch.bfloat16) * 0.05)(B, Sq, D)),
            "k_cache": _w((lambda *s: torch.randn(*s, dtype=torch.bfloat16) * 3.2)(B, Hkv, Sk, Dh)),
            "v_cache": _w((lambda *s: torch.randn(*s, dtype=torch.bfloat16) * 0.4)(B, Hkv, Sk, Dh)),
            "wq": _w((lambda *s: torch.randn(*s, dtype=torch.bfloat16) * 3.2)(D, Hq * Dh) * (D ** -0.5)),
            "wo": _w((lambda *s: torch.randn(*s, dtype=torch.bfloat16) * 0.4)(Hq * Dh, D) * ((Hq * Dh) ** -0.5)),
        }
    _A_in = _A_setup()

    def _B_setup():
        B, S, D, F = 4, 1, 512, 1792
        return {
            "x": _w((lambda *s: torch.randn(*s, dtype=torch.bfloat16) * 0.05)(B, S, D)),
            "w1": _w((lambda *s: torch.randn(*s, dtype=torch.bfloat16) * 0.05)(D, F)),
            "b1": _w((lambda *s: torch.randn(*s, dtype=torch.bfloat16) * 0.8)(F)),
            "w2": _w((lambda *s: torch.randn(*s, dtype=torch.bfloat16) * 0.05)(F, D)),
            "b2": _w((lambda *s: torch.randn(*s, dtype=torch.bfloat16) * 3.2)(D)),
        }
    _B_in = _B_setup()

    return {
        "A_x": _A_in["x"],
        "A_k_cache": _A_in["k_cache"],
        "A_v_cache": _A_in["v_cache"],
        "A_wq": _A_in["wq"],
        "A_wo": _A_in["wo"],
        "B_x": _B_in["x"],
        "B_w1": _B_in["w1"],
        "B_b1": _B_in["b1"],
        "B_w2": _B_in["w2"],
        "B_b2": _B_in["b2"],
    }

def reference(A_x, A_k_cache, A_v_cache, A_wq, A_wo, B_x, B_w1, B_b1, B_w2, B_b2):
    def _A_ref(x, k_cache, v_cache, wq, wo):
        B, Sq, D = x.shape
        Hq, Dh = 32, 128
        Hkv = k_cache.shape[1]
        rep = Hq // Hkv
        q = (lambda x, *d: x.permute(*d))((x @ wq).reshape(B, Sq, Hq, Dh), 0, 2, 1, 3)
        k = (lambda x, n, axis: torch.repeat_interleave(x, n, dim=axis))(k_cache, rep, axis=1)
        v = (lambda x, n, axis: torch.repeat_interleave(x, n, dim=axis))(v_cache, rep, axis=1)
        scores = torch.einsum("bhqd,bhkd->bhqk", q, k) * (Dh ** -0.5)
        p = _softmax(scores, axis=-1)
        o = torch.einsum("bhqk,bhkd->bhqd", p, v)
        return (lambda x, *d: x.permute(*d))(o, 0, 2, 1, 3).reshape(B, Sq, Hq * Dh) @ wo

    def _B_ref(x, w1, b1, w2, b2):
        h = torch.einsum("bsd,df->bsf", x, w1) + b1
        zero = torch.zeros_like(h)
        r = torch.where(h > zero, h, zero)
        h = r * r
        out = torch.einsum("bsf,fd->bsd", h, w2) + b2
        return out

    x = A_x
    h = x + _A_ref(_layernorm(x, axis=-1), A_k_cache, A_v_cache, A_wq, A_wo)
    h2 = h + _B_ref(_layernorm(h, axis=-1), B_w1, B_b1, B_w2, B_b2)
    return h2
```

```asm
; @launch grid=(256,1,1) block=(512,1,1) lds=157184
.amdgcn_target "amdgcn-amd-amdhsa--gfx950"
.text
.globl sequential_preLN__gqa_block_cached__dense_activation_squared_relu__decode_kernel
.p2align 8
.type sequential_preLN__gqa_block_cached__dense_activation_squared_relu__decode_kernel,@function
sequential_preLN__gqa_block_cached__dense_activation_squared_relu__decode_kernel:
  s_cmp_ge_u32 s2, 256
  s_cbranch_scc1 L_end
  s_load_dwordx16 s[8:23], s[0:1], 0
  s_load_dwordx8 s[24:31], s[0:1], 64
  s_load_dwordx2 s[44:45], s[0:1], 96
  s_getpc_b64 s[34:35]
L_pc0:
  v_subrev_u32 v4, 64, v0
  v_lshlrev_b32 v4, 7, v4
  v_cmp_gt_u32 vcc, L_end-L_pc0, v4
  s_and_saveexec_b64 s[66:67], vcc
  s_cbranch_execz L_nw0
  global_load_dword v6, v4, s[34:35]
L_nw0:
  s_mov_b64 exec, -1
  v_lshrrev_b32 v1, 6, v0
  s_and_b32 s4, s2, 7
  v_readfirstlane_b32 s3, v1
  v_and_b32 v1, 63, v0
  s_lshr_b32 s7, s2, 3
  s_lshr_b32 s6, s2, 6
  s_and_b32 s5, s7, 7
  v_lshrrev_b32 v8, 4, v1
  v_bfe_u32 v9, v1, 2, 2
  v_and_b32 v10, 3, v1
  s_lshl3_add_u32 s66, s6, s4
  v_lshlrev_b32 v3, 6, v8
  s_lshl3_add_u32 s66, s66, s5
  v_lshl_add_u32 v3, v9, 8, v3
  s_lshl_b32 s66, s66, 18
  s_lshl_b32 s67, s3, 12
  v_lshl_add_u32 v3, v10, 4, v3
  s_bitset0_b32 s66, 18
  s_and_b32 s38, s5, 1
  s_lshl_b32 s38, s38, 16
  s_add_u32 s67, s67, s38
  s_add_u32 s66, s66, s67
  s_sub_u32 s38, 524288, s67
  s_mov_b32 s39, 0x20000
  s_waitcnt lgkmcnt(0)
  s_add_u32 s36, s10, s66
  s_addc_u32 s37, s11, 0
  buffer_load_dwordx4 v[112:115], v3, s[36:39], 0 offen offset:0 nt
  buffer_load_dwordx4 v[116:119], v3, s[36:39], 0 offen offset:1024 nt
  buffer_load_dwordx4 v[120:123], v3, s[36:39], 0 offen offset:2048 nt
  buffer_load_dwordx4 v[124:127], v3, s[36:39], 0 offen offset:3072 nt
  s_memrealtime s[64:65]
  s_add_u32 s40, s12, s66
  s_addc_u32 s41, s13, 0
  s_mov_b32 s42, s38
  s_mov_b32 s43, 0x20000
  s_mov_b32 s46, 0x10000000
  s_mov_b32 s47, 0x20000
  s_mov_b32 s72, 0x05040100
  s_mov_b32 s73, 0x07060302
  v_lshlrev_b32 v2, 4, v1
  s_mov_b32 s52, 32768
  s_mov_b32 s53, 131072
  s_mov_b32 s54, 163840
  s_mov_b32 s55, 262144
  s_mov_b32 s56, 294912
  s_mov_b32 s57, 393216
  s_mov_b32 s58, 425984
  s_cmp_eq_u32 s3, 0
  s_cbranch_scc1 L_qwave
L_ord:
  s_waitcnt vmcnt(3)
  buffer_load_dwordx4 v[128:131], v3, s[36:39], s52 offen offset:0 nt
  s_waitcnt vmcnt(3)
  buffer_load_dwordx4 v[132:135], v3, s[36:39], s52 offen offset:1024 nt
  s_waitcnt vmcnt(3)
  buffer_load_dwordx4 v[136:139], v3, s[36:39], s52 offen offset:2048 nt
  s_waitcnt vmcnt(3)
  buffer_load_dwordx4 v[140:143], v3, s[36:39], s52 offen offset:3072 nt
  s_waitcnt vmcnt(3)
  buffer_load_dwordx4 v[144:147], v3, s[36:39], s53 offen offset:0 nt
  s_lshl_b32 s66, s4, 19
  s_lshl_b32 s67, s3, 16
  s_add_u32 s66, s66, s67
  s_xor_b32 s67, s5, 4
  s_lshl_b32 s67, s67, 7
  s_add_u32 s66, s66, s67
  s_add_u32 s16, s16, s66
  s_addc_u32 s17, s17, 0
  s_mov_b32 s18, 0x400000
  s_sub_u32 s18, s18, s66
  s_mov_b32 s19, 0x20000
  s_cmp_eq_u32 s5, 7
  s_cselect_b32 s75, 1, s5
  s_add_u32 s75, s75, s4
  s_add_u32 s75, s75, 6
  s_sub_u32 s66, s75, 7
  s_cmp_ge_u32 s75, 7
  s_cselect_b32 s75, s66, s75
  s_sub_u32 s66, s75, 7
  s_cmp_ge_u32 s75, 7
  s_cselect_b32 s75, s66, s75
  s_mul_i32 s66, s4, 7
  s_add_u32 s75, s75, s66
  s_mul_i32 s66, s3, 229376
  s_lshl_b32 s67, s75, 6
  s_add_u32 s66, s66, s67
  s_add_u32 s48, s20, s66
  s_addc_u32 s49, s21, 0
  s_sub_u32 s50, 1835008, s66
  s_mov_b32 s51, 0x20000
  s_lshl_b32 s66, s75, 15
  s_lshl_b32 s67, s3, 7
  s_add_u32 s66, s66, s67
  s_add_u32 s60, s24, s66
  s_addc_u32 s61, s25, 0
  s_sub_u32 s62, 1835008, s66
  s_mov_b32 s63, 0x20000
  s_cmp_eq_u32 s5, 7
  s_cselect_b32 s50, 0, s50
  s_cselect_b32 s62, 0, s62
  s_lshl_b32 s34, s3, 14
  v_and_b32 v14, 7, v1
  v_lshlrev_b32 v15, 1, v8
  v_xor_b32 v14, v14, v15
  v_lshlrev_b32 v14, 4, v14
  v_lshrrev_b32 v13, 3, v1
  v_lshl_add_u32 v13, v13, 10, v14
  v_bfe_u32 v11, v1, 3, 2
  v_lshlrev_b32 v11, 2, v11
  v_lshrrev_b32 v12, 5, v1
  v_add_u32 v11, v11, v12
  v_lshl_add_u32 v11, v11, 10, v14
  v_lshl_add_u32 v12, v8, 4, v9
  v_mul_u32_u24 v12, 3584, v12
  v_and_b32 v15, 2, v15
  v_xor_b32 v14, v10, v15
  v_lshl_add_u32 v12, v14, 4, v12
  s_waitcnt vmcnt(3)
  buffer_load_dwordx4 v[148:151], v3, s[36:39], s53 offen offset:1024 nt
  s_waitcnt vmcnt(3)
  buffer_load_dwordx4 v[152:155], v3, s[36:39], s53 offen offset:2048 nt
  s_waitcnt vmcnt(3)
  buffer_load_dwordx4 v[156:159], v3, s[36:39], s53 offen offset:3072 nt
  s_lshl_b32 s66, s6, 10
  s_lshl_b32 s67, s3, 7
  s_add_u32 s66, s66, s67
  v_lshl_add_u32 v23, v1, 1, s66
  global_load_ushort v20, v23, s[8:9]
  s_waitcnt vmcnt(4)
  buffer_load_dwordx4 v[160:163], v3, s[36:39], s54 offen offset:0 nt
  s_waitcnt vmcnt(4)
  buffer_load_dwordx4 v[164:167], v3, s[36:39], s54 offen offset:1024 nt
  s_lshl_b32 s66, s75, 6
  v_bfe_u32 v23, v1, 2, 1
  v_lshlrev_b32 v23, 2, v23
  v_add_u32 v23, v23, v8
  v_lshl_add_u32 v23, v23, 2, v10
  v_lshl_add_u32 v23, v23, 1, s66
  global_load_ushort v21, v23, s[22:23]
  s_waitcnt vmcnt(5)
  buffer_load_dwordx4 v[168:171], v3, s[36:39], s54 offen offset:2048 nt
  s_waitcnt vmcnt(5)
  buffer_load_dwordx4 v[172:175], v3, s[36:39], s54 offen offset:3072 nt
  s_lshl_b32 s66, s4, 6
  s_lshl_b32 s67, s5, 3
  s_add_u32 s66, s66, s67
  v_and_b32 v23, 7, v1
  v_bfe_u32 v19, v1, 3, 2
  v_lshl_add_u32 v23, v19, 4, v23
  v_add_u32 v19, s66, v23
  v_and_b32 v19, 511, v19
  v_lshlrev_b32 v23, 1, v19
  global_load_ushort v22, v23, s[26:27]
  s_waitcnt vmcnt(5)
  buffer_load_dwordx4 v[176:179], v3, s[36:39], s55 offen offset:0 nt
  s_waitcnt vmcnt(5)
  buffer_load_dwordx4 v[180:183], v3, s[36:39], s55 offen offset:1024 nt
  s_add_u32 m0, s34, 26112
  s_mov_b32 s67, 0
  buffer_load_dwordx4 v11, s[16:19], s67 offen  lds
  s_waitcnt vmcnt(5)
  buffer_load_dwordx4 v[184:187], v3, s[36:39], s55 offen offset:2048 nt
  s_waitcnt vmcnt(5)
  buffer_load_dwordx4 v[188:191], v3, s[36:39], s55 offen offset:3072 nt
  s_add_u32 m0, s34, 34304
  s_mov_b32 s67, 0
  buffer_load_dwordx4 v12, s[48:51], s67 offen  lds
  s_waitcnt vmcnt(5)
  buffer_load_dwordx4 v[192:195], v3, s[36:39], s56 offen offset:0 nt
  s_waitcnt vmcnt(5)
  buffer_load_dwordx4 v[196:199], v3, s[36:39], s56 offen offset:1024 nt
  s_add_u32 m0, s34, 27136
  s_mov_b32 s67, 2048
  buffer_load_dwordx4 v11, s[16:19], s67 offen  lds
  s_waitcnt vmcnt(5)
  buffer_load_dwordx4 v[200:203], v3, s[36:39], s56 offen offset:2048 nt
  s_waitcnt vmcnt(5)
  buffer_load_dwordx4 v[204:207], v3, s[36:39], s56 offen offset:3072 nt
  s_add_u32 m0, s34, 28160
  s_mov_b32 s67, 16384
  buffer_load_dwordx4 v11, s[16:19], s67 offen  lds
  s_waitcnt vmcnt(5)
  buffer_load_dwordx4 v[208:211], v3, s[36:39], s57 offen offset:0 nt
  s_waitcnt vmcnt(5)
  buffer_load_dwordx4 v[212:215], v3, s[36:39], s57 offen offset:1024 nt
  s_add_u32 m0, s34, 35328
  s_mov_b32 s67, 14336
  buffer_load_dwordx4 v12, s[48:51], s67 offen  lds
  s_waitcnt vmcnt(5)
  buffer_load_dwordx4 v[216:219], v3, s[36:39], s57 offen offset:2048 nt
  s_waitcnt vmcnt(5)
  buffer_load_dwordx4 v[220:223], v3, s[36:39], s57 offen offset:3072 nt
  s_add_u32 m0, s34, 29184
  s_mov_b32 s67, 18432
  buffer_load_dwordx4 v11, s[16:19], s67 offen  lds
  s_waitcnt vmcnt(5)
  buffer_load_dwordx4 v[224:227], v3, s[36:39], s58 offen offset:0 nt
  s_waitcnt vmcnt(5)
  buffer_load_dwordx4 v[228:231], v3, s[36:39], s58 offen offset:1024 nt
  s_waitcnt vmcnt(4)
  buffer_load_dwordx4 v[232:235], v3, s[36:39], s58 offen offset:2048 nt
  s_add_u32 m0, s34, 30208
  s_mov_b32 s67, 32768
  buffer_load_dwordx4 v11, s[16:19], s67 offen  lds
  s_waitcnt vmcnt(5)
  buffer_load_dwordx4 v[236:239], v3, s[36:39], s58 offen offset:3072 nt
  s_waitcnt vmcnt(4)
  buffer_load_dwordx4 v[240:243], v2, s[40:43], 0 offen offset:0 nt
  s_waitcnt vmcnt(4)
  buffer_load_dwordx4 v[244:247], v2, s[40:43], 0 offen offset:1024 nt
  s_waitcnt vmcnt(4)
  buffer_load_dwordx4 v[248:251], v2, s[40:43], 0 offen offset:2048 nt
  s_waitcnt vmcnt(3)
  buffer_load_dwordx4 v[252:255], v2, s[40:43], 0 offen offset:3072 nt
  s_branch L_b1
L_qwave:
  s_setprio 3
  s_waitcnt lgkmcnt(0)
  s_mov_b32 s12, s64
  s_cmp_lg_u32 s2, 0
  s_cbranch_scc1 L_nononce
  s_or_b32 s64, s64, 1
  v_mov_b32 v11, 0
  v_mov_b32 v12, s64
  global_store_dword v11, v12, s[30:31] sc1
L_nononce:
  v_lshlrev_b32 v11, 10, v10
  v_lshl_add_u32 v11, v8, 4, v11
  s_lshl_b32 s66, s6, 8
  v_add_u32 v46, s66, v11
  v_lshl_add_u32 v11, v9, 8, v11
  global_load_dwordx4 v[12:15], v11, s[8:9] offset:0
  global_load_dwordx4 v[16:19], v11, s[8:9] offset:64
  global_load_dwordx4 v[20:23], v11, s[8:9] offset:128
  global_load_dwordx4 v[24:27], v11, s[8:9] offset:192
  global_load_dwordx4 v[96:99], v46, s[8:9] offset:0
  global_load_dwordx4 v[100:103], v46, s[8:9] offset:64
  global_load_dwordx4 v[104:107], v46, s[8:9] offset:128
  global_load_dwordx4 v[108:111], v46, s[8:9] offset:192
  s_lshl_b32 s66, s4, 10
  s_xor_b32 s67, s5, 4
  s_lshl_b32 s67, s67, 7
  s_add_u32 s66, s66, s67
  s_lshl_b32 s67, s6, 20
  s_add_u32 s66, s66, s67
  s_add_u32 s60, s14, s66
  s_addc_u32 s61, s15, 0
  s_mov_b32 s62, 0x400000
  s_sub_u32 s62, s62, s66
  s_mov_b32 s63, 0x20000
  v_lshrrev_b32 v28, 3, v1
  v_lshlrev_b32 v28, 13, v28
  v_and_b32 v29, 7, v1
  v_lshlrev_b32 v30, 1, v8
  v_xor_b32 v29, v29, v30
  v_lshl_add_u32 v28, v29, 4, v28
  s_mov_b32 m0, 26112
  s_mov_b32 s66, 0
  buffer_load_dwordx4 v28, s[60:63], s66 offen nt lds
  s_add_u32 m0, m0, 1024
  s_add_u32 s66, s66, 0x10000
  buffer_load_dwordx4 v28, s[60:63], s66 offen nt lds
  s_add_u32 m0, m0, 1024
  s_add_u32 s66, s66, 0x10000
  buffer_load_dwordx4 v28, s[60:63], s66 offen nt lds
  s_add_u32 m0, m0, 1024
  s_add_u32 s66, s66, 0x10000
  buffer_load_dwordx4 v28, s[60:63], s66 offen nt lds
  s_add_u32 m0, m0, 1024
  s_add_u32 s66, s66, 0x10000
  buffer_load_dwordx4 v28, s[60:63], s66 offen nt lds
  s_add_u32 m0, m0, 1024
  s_add_u32 s66, s66, 0x10000
  buffer_load_dwordx4 v28, s[60:63], s66 offen nt lds
  s_add_u32 m0, m0, 1024
  s_add_u32 s66, s66, 0x10000
  buffer_load_dwordx4 v28, s[60:63], s66 offen nt lds
  s_add_u32 m0, m0, 1024
  s_add_u32 s66, s66, 0x10000
  buffer_load_dwordx4 v28, s[60:63], s66 offen nt lds
  s_add_u32 m0, m0, 1024
  s_add_u32 s66, s66, 0x10000
  buffer_load_dwordx4 v28, s[60:63], s66 offen nt lds
  s_add_u32 m0, m0, 1024
  s_add_u32 s66, s66, 0x10000
  buffer_load_dwordx4 v28, s[60:63], s66 offen nt lds
  s_add_u32 m0, m0, 1024
  s_add_u32 s66, s66, 0x10000
  buffer_load_dwordx4 v28, s[60:63], s66 offen nt lds
  s_add_u32 m0, m0, 1024
  s_add_u32 s66, s66, 0x10000
  buffer_load_dwordx4 v28, s[60:63], s66 offen nt lds
  s_add_u32 m0, m0, 1024
  s_add_u32 s66, s66, 0x10000
  buffer_load_dwordx4 v28, s[60:63], s66 offen nt lds
  s_add_u32 m0, m0, 1024
  s_add_u32 s66, s66, 0x10000
  buffer_load_dwordx4 v28, s[60:63], s66 offen nt lds
  s_add_u32 m0, m0, 1024
  s_add_u32 s66, s66, 0x10000
  buffer_load_dwordx4 v28, s[60:63], s66 offen nt lds
  s_add_u32 m0, m0, 1024
  s_add_u32 s66, s66, 0x10000
  buffer_load_dwordx4 v28, s[60:63], s66 offen nt lds
  buffer_load_dwordx4 v[128:131], v3, s[36:39], s52 offen offset:0 nt
  buffer_load_dwordx4 v[132:135], v3, s[36:39], s52 offen offset:1024 nt
  buffer_load_dwordx4 v[136:139], v3, s[36:39], s52 offen offset:2048 nt
  buffer_load_dwordx4 v[140:143], v3, s[36:39], s52 offen offset:3072 nt
  v_mov_b32 v11, 0
  s_waitcnt vmcnt(24)
  global_load_dword v44, v11, s[30:31] sc1
  v_lshlrev_b32 v48, 16, v12
  v_and_b32 v49, 0xffff0000, v12
  v_lshlrev_b32 v50, 16, v13
  v_and_b32 v51, 0xffff0000, v13
  v_lshlrev_b32 v52, 16, v14
  v_and_b32 v53, 0xffff0000, v14
  v_lshlrev_b32 v54, 16, v15
  v_and_b32 v55, 0xffff0000, v15
  v_lshlrev_b32 v56, 16, v16
  v_and_b32 v57, 0xffff0000, v16
  v_lshlrev_b32 v58, 16, v17
  v_and_b32 v59, 0xffff0000, v17
  v_lshlrev_b32 v60, 16, v18
  v_and_b32 v61, 0xffff0000, v18
  v_lshlrev_b32 v62, 16, v19
  v_and_b32 v63, 0xffff0000, v19
  v_lshlrev_b32 v64, 16, v20
  v_and_b32 v65, 0xffff0000, v20
  v_lshlrev_b32 v66, 16, v21
  v_and_b32 v67, 0xffff0000, v21
  v_lshlrev_b32 v68, 16, v22
  v_and_b32 v69, 0xffff0000, v22
  v_lshlrev_b32 v70, 16, v23
  v_and_b32 v71, 0xffff0000, v23
  v_lshlrev_b32 v72, 16, v24
  v_and_b32 v73, 0xffff0000, v24
  v_lshlrev_b32 v74, 16, v25
  v_and_b32 v75, 0xffff0000, v25
  v_lshlrev_b32 v76, 16, v26
  v_and_b32 v77, 0xffff0000, v26
  v_lshlrev_b32 v78, 16, v27
  v_and_b32 v79, 0xffff0000, v27
  v_add_f32 v30, v48, v49
  v_add_f32 v31, v50, v51
  v_add_f32 v30, v30, v52
  v_add_f32 v31, v31, v53
  v_add_f32 v30, v30, v54
  v_add_f32 v31, v31, v55
  v_add_f32 v30, v30, v56
  v_add_f32 v31, v31, v57
  v_add_f32 v30, v30, v58
  v_add_f32 v31, v31, v59
  v_add_f32 v30, v30, v60
  v_add_f32 v31, v31, v61
  v_add_f32 v30, v30, v62
  v_add_f32 v31, v31, v63
  v_add_f32 v30, v30, v64
  v_add_f32 v31, v31, v65
  v_add_f32 v30, v30, v66
  v_add_f32 v31, v31, v67
  v_add_f32 v30, v30, v68
  v_add_f32 v31, v31, v69
  v_add_f32 v30, v30, v70
  v_add_f32 v31, v31, v71
  v_add_f32 v30, v30, v72
  v_add_f32 v31, v31, v73
  v_add_f32 v30, v30, v74
  v_add_f32 v31, v31, v75
  v_add_f32 v30, v30, v76
  v_add_f32 v31, v31, v77
  v_add_f32 v30, v30, v78
  v_add_f32 v31, v31, v79
  v_add_f32 v30, v30, v31
  s_nop 1
  v_add_f32_dpp v30, v30, v30 row_ror:4 row_mask:0xf bank_mask:0xf
  s_nop 1
  v_add_f32_dpp v30, v30, v30 row_ror:8 row_mask:0xf bank_mask:0xf
  v_mov_b32 v31, v30
  s_nop 1
  v_permlane16_swap_b32 v31, v30
  v_add_f32 v30, v31, v30
  v_mov_b32 v31, v30
  s_nop 1
  v_permlane32_swap_b32 v31, v30
  v_add_f32 v30, v31, v30
  v_mul_f32 v30, 0x3b000000, v30
  v_sub_f32 v33, v48, v30
  v_sub_f32 v34, v49, v30
  v_mul_f32 v31, v33, v33
  v_mul_f32 v32, v34, v34
  v_sub_f32 v33, v50, v30
  v_sub_f32 v34, v51, v30
  v_fmac_f32 v31, v33, v33
  v_fmac_f32 v32, v34, v34
  v_sub_f32 v33, v52, v30
  v_sub_f32 v34, v53, v30
  v_fmac_f32 v31, v33, v33
  v_fmac_f32 v32, v34, v34
  v_sub_f32 v33, v54, v30
  v_sub_f32 v34, v55, v30
  v_fmac_f32 v31, v33, v33
  v_fmac_f32 v32, v34, v34
  v_sub_f32 v33, v56, v30
  v_sub_f32 v34, v57, v30
  v_fmac_f32 v31, v33, v33
  v_fmac_f32 v32, v34, v34
  v_sub_f32 v33, v58, v30
  v_sub_f32 v34, v59, v30
  v_fmac_f32 v31, v33, v33
  v_fmac_f32 v32, v34, v34
  v_sub_f32 v33, v60, v30
  v_sub_f32 v34, v61, v30
  v_fmac_f32 v31, v33, v33
  v_fmac_f32 v32, v34, v34
  v_sub_f32 v33, v62, v30
  v_sub_f32 v34, v63, v30
  v_fmac_f32 v31, v33, v33
  v_fmac_f32 v32, v34, v34
  v_sub_f32 v33, v64, v30
  v_sub_f32 v34, v65, v30
  v_fmac_f32 v31, v33, v33
  v_fmac_f32 v32, v34, v34
  v_sub_f32 v33, v66, v30
  v_sub_f32 v34, v67, v30
  v_fmac_f32 v31, v33, v33
  v_fmac_f32 v32, v34, v34
  v_sub_f32 v33, v68, v30
  v_sub_f32 v34, v69, v30
  v_fmac_f32 v31, v33, v33
  v_fmac_f32 v32, v34, v34
  v_sub_f32 v33, v70, v30
  v_sub_f32 v34, v71, v30
  v_fmac_f32 v31, v33, v33
  v_fmac_f32 v32, v34, v34
  v_sub_f32 v33, v72, v30
  v_sub_f32 v34, v73, v30
  v_fmac_f32 v31, v33, v33
  v_fmac_f32 v32, v34, v34
  v_sub_f32 v33, v74, v30
  v_sub_f32 v34, v75, v30
  v_fmac_f32 v31, v33, v33
  v_fmac_f32 v32, v34, v34
  v_sub_f32 v33, v76, v30
  v_sub_f32 v34, v77, v30
  v_fmac_f32 v31, v33, v33
  v_fmac_f32 v32, v34, v34
  v_sub_f32 v33, v78, v30
  v_sub_f32 v34, v79, v30
  v_fmac_f32 v31, v33, v33
  v_fmac_f32 v32, v34, v34
  v_add_f32 v31, v31, v32
  s_nop 1
  v_add_f32_dpp v31, v31, v31 row_ror:4 row_mask:0xf bank_mask:0xf
  s_nop 1
  v_add_f32_dpp v31, v31, v31 row_ror:8 row_mask:0xf bank_mask:0xf
  v_mov_b32 v32, v31
  s_nop 1
  v_permlane16_swap_b32 v32, v31
  v_add_f32 v31, v32, v31
  v_mov_b32 v32, v31
  s_nop 1
  v_permlane32_swap_b32 v32, v31
  v_add_f32 v31, v32, v31
  v_mul_f32 v31, 0x3b000000, v31
  v_cvt_pk_bf16_f32 v32, v30, v31
  v_lshlrev_b32 v30, 16, v32
  v_and_b32 v31, 0xffff0000, v32
  v_add_f32 v31, 0x3727c5ac, v31
  v_cvt_pk_bf16_f32 v31, v31, v31
  v_and_b32 v31, 0xffff0000, v31
  v_sqrt_f32 v31, v31
  s_nop 0
  v_cvt_pk_bf16_f32 v31, v31, v31
  v_and_b32 v31, 0xffff0000, v31
  v_rcp_f32 v31, v31
  s_waitcnt vmcnt(21)
  v_lshlrev_b32 v34, 16, v96
  v_and_b32 v35, 0xffff0000, v96
  v_sub_f32 v34, v34, v30
  v_sub_f32 v35, v35, v30
  v_cvt_pk_bf16_f32 v33, v34, v35
  v_lshlrev_b32 v34, 16, v33
  v_and_b32 v35, 0xffff0000, v33
  v_mul_f32 v34, v34, v31
  v_mul_f32 v35, v35, v31
  v_cvt_pk_bf16_f32 v12, v34, v35
  v_lshlrev_b32 v34, 16, v97
  v_and_b32 v35, 0xffff0000, v97
  v_sub_f32 v34, v34, v30
  v_sub_f32 v35, v35, v30
  v_cvt_pk_bf16_f32 v33, v34, v35
  v_lshlrev_b32 v34, 16, v33
  v_and_b32 v35, 0xffff0000, v33
  v_mul_f32 v34, v34, v31
  v_mul_f32 v35, v35, v31
  v_cvt_pk_bf16_f32 v13, v34, v35
  v_lshlrev_b32 v34, 16, v98
  v_and_b32 v35, 0xffff0000, v98
  v_sub_f32 v34, v34, v30
  v_sub_f32 v35, v35, v30
  v_cvt_pk_bf16_f32 v33, v34, v35
  v_lshlrev_b32 v34, 16, v33
  v_and_b32 v35, 0xffff0000, v33
  v_mul_f32 v34, v34, v31
  v_mul_f32 v35, v35, v31
  v_cvt_pk_bf16_f32 v14, v34, v35
  v_lshlrev_b32 v34, 16, v99
  v_and_b32 v35, 0xffff0000, v99
  v_sub_f32 v34, v34, v30
  v_sub_f32 v35, v35, v30
  v_cvt_pk_bf16_f32 v33, v34, v35
  v_lshlrev_b32 v34, 16, v33
  v_and_b32 v35, 0xffff0000, v33
  v_mul_f32 v34, v34, v31
  v_mul_f32 v35, v35, v31
  v_cvt_pk_bf16_f32 v15, v34, v35
  v_lshlrev_b32 v34, 16, v100
  v_and_b32 v35, 0xffff0000, v100
  v_sub_f32 v34, v34, v30
  v_sub_f32 v35, v35, v30
  v_cvt_pk_bf16_f32 v33, v34, v35
  v_lshlrev_b32 v34, 16, v33
  v_and_b32 v35, 0xffff0000, v33
  v_mul_f32 v34, v34, v31
  v_mul_f32 v35, v35, v31
  v_cvt_pk_bf16_f32 v16, v34, v35
  v_lshlrev_b32 v34, 16, v101
  v_and_b32 v35, 0xffff0000, v101
  v_sub_f32 v34, v34, v30
  v_sub_f32 v35, v35, v30
  v_cvt_pk_bf16_f32 v33, v34, v35
  v_lshlrev_b32 v34, 16, v33
  v_and_b32 v35, 0xffff0000, v33
  v_mul_f32 v34, v34, v31
  v_mul_f32 v35, v35, v31
  v_cvt_pk_bf16_f32 v17, v34, v35
  v_lshlrev_b32 v34, 16, v102
  v_and_b32 v35, 0xffff0000, v102
  v_sub_f32 v34, v34, v30
  v_sub_f32 v35, v35, v30
  v_cvt_pk_bf16_f32 v33, v34, v35
  v_lshlrev_b32 v34, 16, v33
  v_and_b32 v35, 0xffff0000, v33
  v_mul_f32 v34, v34, v31
  v_mul_f32 v35, v35, v31
  v_cvt_pk_bf16_f32 v18, v34, v35
  v_lshlrev_b32 v34, 16, v103
  v_and_b32 v35, 0xffff0000, v103
  v_sub_f32 v34, v34, v30
  v_sub_f32 v35, v35, v30
  v_cvt_pk_bf16_f32 v33, v34, v35
  v_lshlrev_b32 v34, 16, v33
  v_and_b32 v35, 0xffff0000, v33
  v_mul_f32 v34, v34, v31
  v_mul_f32 v35, v35, v31
  v_cvt_pk_bf16_f32 v19, v34, v35
  v_lshlrev_b32 v34, 16, v104
  v_and_b32 v35, 0xffff0000, v104
  v_sub_f32 v34, v34, v30
  v_sub_f32 v35, v35, v30
  v_cvt_pk_bf16_f32 v33, v34, v35
  v_lshlrev_b32 v34, 16, v33
  v_and_b32 v35, 0xffff0000, v33
  v_mul_f32 v34, v34, v31
  v_mul_f32 v35, v35, v31
  v_cvt_pk_bf16_f32 v20, v34, v35
  v_lshlrev_b32 v34, 16, v105
  v_and_b32 v35, 0xffff0000, v105
  v_sub_f32 v34, v34, v30
  v_sub_f32 v35, v35, v30
  v_cvt_pk_bf16_f32 v33, v34, v35
  v_lshlrev_b32 v34, 16, v33
  v_and_b32 v35, 0xffff0000, v33
  v_mul_f32 v34, v34, v31
  v_mul_f32 v35, v35, v31
  v_cvt_pk_bf16_f32 v21, v34, v35
  v_lshlrev_b32 v34, 16, v106
  v_and_b32 v35, 0xffff0000, v106
  v_sub_f32 v34, v34, v30
  v_sub_f32 v35, v35, v30
  v_cvt_pk_bf16_f32 v33, v34, v35
  v_lshlrev_b32 v34, 16, v33
  v_and_b32 v35, 0xffff0000, v33
  v_mul_f32 v34, v34, v31
  v_mul_f32 v35, v35, v31
  v_cvt_pk_bf16_f32 v22, v34, v35
  v_lshlrev_b32 v34, 16, v107
  v_and_b32 v35, 0xffff0000, v107
  v_sub_f32 v34, v34, v30
  v_sub_f32 v35, v35, v30
  v_cvt_pk_bf16_f32 v33, v34, v35
  v_lshlrev_b32 v34, 16, v33
  v_and_b32 v35, 0xffff0000, v33
  v_mul_f32 v34, v34, v31
  v_mul_f32 v35, v35, v31
  v_cvt_pk_bf16_f32 v23, v34, v35
  v_lshlrev_b32 v34, 16, v108
  v_and_b32 v35, 0xffff0000, v108
  v_sub_f32 v34, v34, v30
  v_sub_f32 v35, v35, v30
  v_cvt_pk_bf16_f32 v33, v34, v35
  v_lshlrev_b32 v34, 16, v33
  v_and_b32 v35, 0xffff0000, v33
  v_mul_f32 v34, v34, v31
  v_mul_f32 v35, v35, v31
  v_cvt_pk_bf16_f32 v24, v34, v35
  v_lshlrev_b32 v34, 16, v109
  v_and_b32 v35, 0xffff0000, v109
  v_sub_f32 v34, v34, v30
  v_sub_f32 v35, v35, v30
  v_cvt_pk_bf16_f32 v33, v34, v35
  v_lshlrev_b32 v34, 16, v33
  v_and_b32 v35, 0xffff0000, v33
  v_mul_f32 v34, v34, v31
  v_mul_f32 v35, v35, v31
  v_cvt_pk_bf16_f32 v25, v34, v35
  v_lshlrev_b32 v34, 16, v110
  v_and_b32 v35, 0xffff0000, v110
  v_sub_f32 v34, v34, v30
  v_sub_f32 v35, v35, v30
  v_cvt_pk_bf16_f32 v33, v34, v35
  v_lshlrev_b32 v34, 16, v33
  v_and_b32 v35, 0xffff0000, v33
  v_mul_f32 v34, v34, v31
  v_mul_f32 v35, v35, v31
  v_cvt_pk_bf16_f32 v26, v34, v35
  v_lshlrev_b32 v34, 16, v111
  v_and_b32 v35, 0xffff0000, v111
  v_sub_f32 v34, v34, v30
  v_sub_f32 v35, v35, v30
  v_cvt_pk_bf16_f32 v33, v34, v35
  v_lshlrev_b32 v34, 16, v33
  v_and_b32 v35, 0xffff0000, v33
  v_mul_f32 v34, v34, v31
  v_mul_f32 v35, v35, v31
  v_cvt_pk_bf16_f32 v27, v34, v35
  v_lshl_add_u32 v29, v8, 3, v9
  v_lshlrev_b32 v36, 7, v29
  v_lshrrev_b32 v29, 1, v9
  v_lshl_add_u32 v36, v29, 5, v36
  v_lshl_add_u32 v36, v10, 3, v36
  v_xor_b32 v37, 32, v36
  v_xor_b32 v38, 64, v36
  v_xor_b32 v39, 0x60, v36
  s_waitcnt vmcnt(5)
  ds_read_b64_tr_b16 v[48:49], v36 offset:26112
  ds_read_b64_tr_b16 v[50:51], v38 offset:26624
  ds_read_b64_tr_b16 v[52:53], v37 offset:26112
  ds_read_b64_tr_b16 v[54:55], v39 offset:26624
  ds_read_b64_tr_b16 v[56:57], v38 offset:26112
  ds_read_b64_tr_b16 v[58:59], v36 offset:26624
  ds_read_b64_tr_b16 v[60:61], v39 offset:26112
  ds_read_b64_tr_b16 v[62:63], v37 offset:26624
  ds_read_b64_tr_b16 v[64:65], v36 offset:30208
  ds_read_b64_tr_b16 v[66:67], v38 offset:30720
  ds_read_b64_tr_b16 v[68:69], v37 offset:30208
  ds_read_b64_tr_b16 v[70:71], v39 offset:30720
  s_waitcnt lgkmcnt(10)
  v_mfma_f32_16x16x32_bf16 v[80:83], v[48:51], v[12:15], 0
  ds_read_b64_tr_b16 v[72:73], v38 offset:30208
  ds_read_b64_tr_b16 v[74:75], v36 offset:30720
  s_waitcnt lgkmcnt(10)
  v_mfma_f32_16x16x32_bf16 v[84:87], v[52:55], v[12:15], 0
  ds_read_b64_tr_b16 v[76:77], v39 offset:30208
  ds_read_b64_tr_b16 v[78:79], v37 offset:30720
  s_waitcnt lgkmcnt(10)
  v_mfma_f32_16x16x32_bf16 v[88:91], v[56:59], v[12:15], 0
  ds_read_b64_tr_b16 v[48:49], v36 offset:34304
  ds_read_b64_tr_b16 v[50:51], v38 offset:34816
  s_waitcnt lgkmcnt(10)
  v_mfma_f32_16x16x32_bf16 v[92:95], v[60:63], v[12:15], 0
  ds_read_b64_tr_b16 v[52:53], v37 offset:34304
  ds_read_b64_tr_b16 v[54:55], v39 offset:34816
  s_waitcnt lgkmcnt(10)
  v_mfma_f32_16x16x32_bf16 v[80:83], v[64:67], v[16:19], v[80:83]
  ds_read_b64_tr_b16 v[56:57], v38 offset:34304
  ds_read_b64_tr_b16 v[58:59], v36 offset:34816
  s_waitcnt lgkmcnt(10)
  v_mfma_f32_16x16x32_bf16 v[84:87], v[68:71], v[16:19], v[84:87]
  ds_read_b64_tr_b16 v[60:61], v39 offset:34304
  ds_read_b64_tr_b16 v[62:63], v37 offset:34816
  s_waitcnt lgkmcnt(10)
  v_mfma_f32_16x16x32_bf16 v[88:91], v[72:75], v[16:19], v[88:91]
  ds_read_b64_tr_b16 v[64:65], v36 offset:38400
  ds_read_b64_tr_b16 v[66:67], v38 offset:38912
  s_waitcnt lgkmcnt(10)
  v_mfma_f32_16x16x32_bf16 v[92:95], v[76:79], v[16:19], v[92:95]
  ds_read_b64_tr_b16 v[68:69], v37 offset:38400
  ds_read_b64_tr_b16 v[70:71], v39 offset:38912
  s_waitcnt lgkmcnt(10)
  v_mfma_f32_16x16x32_bf16 v[80:83], v[48:51], v[20:23], v[80:83]
  ds_read_b64_tr_b16 v[72:73], v38 offset:38400
  ds_read_b64_tr_b16 v[74:75], v36 offset:38912
  s_waitcnt lgkmcnt(10)
  v_mfma_f32_16x16x32_bf16 v[84:87], v[52:55], v[20:23], v[84:87]
  ds_read_b64_tr_b16 v[76:77], v39 offset:38400
  ds_read_b64_tr_b16 v[78:79], v37 offset:38912
  s_waitcnt lgkmcnt(10)
  v_mfma_f32_16x16x32_bf16 v[88:91], v[56:59], v[20:23], v[88:91]
  s_waitcnt lgkmcnt(8)
  v_mfma_f32_16x16x32_bf16 v[92:95], v[60:63], v[20:23], v[92:95]
  s_waitcnt lgkmcnt(6)
  v_mfma_f32_16x16x32_bf16 v[80:83], v[64:67], v[24:27], v[80:83]
  s_waitcnt lgkmcnt(4)
  v_mfma_f32_16x16x32_bf16 v[84:87], v[68:71], v[24:27], v[84:87]
  s_waitcnt lgkmcnt(2)
  v_mfma_f32_16x16x32_bf16 v[88:91], v[72:75], v[24:27], v[88:91]
  s_waitcnt lgkmcnt(0)
  v_mfma_f32_16x16x32_bf16 v[92:95], v[76:79], v[24:27], v[92:95]
  s_waitcnt vmcnt(0)
  v_readfirstlane_b32 s64, v44
  s_cmp_lg_u32 s64, 0
  s_cbranch_scc1 L_havenonce
  s_mov_b32 s66, 0
L_noncepoll:
  global_load_dword v44, v11, s[30:31] sc1
  s_waitcnt vmcnt(0)
  v_readfirstlane_b32 s64, v44
  s_add_u32 s66, s66, 1
  s_cmp_gt_u32 s66, 1000000
  s_cbranch_scc1 L_havenonce
  s_cmp_eq_u32 s64, 0
  s_cbranch_scc1 L_noncepoll
L_havenonce:
  s_and_b32 s68, s64, 0xff
  s_bfe_u32 s69, s64, 0x80008
  s_bfe_u32 s70, s64, 0x80010
  s_lshr_b32 s71, s64, 24
  v_mov_b32 v18, 0xff
  v_mov_b32_dpp v80, v84 quad_perm:[0,1,2,3] row_mask:0xf bank_mask:0x2
  v_mov_b32_dpp v81, v85 quad_perm:[0,1,2,3] row_mask:0xf bank_mask:0x2
  v_mov_b32_dpp v82, v86 quad_perm:[0,1,2,3] row_mask:0xf bank_mask:0x2
  v_mov_b32_dpp v83, v87 quad_perm:[0,1,2,3] row_mask:0xf bank_mask:0x2
  v_mov_b32_dpp v80, v88 quad_perm:[0,1,2,3] row_mask:0xf bank_mask:0x4
  v_mov_b32_dpp v81, v89 quad_perm:[0,1,2,3] row_mask:0xf bank_mask:0x4
  v_mov_b32_dpp v82, v90 quad_perm:[0,1,2,3] row_mask:0xf bank_mask:0x4
  v_mov_b32_dpp v83, v91 quad_perm:[0,1,2,3] row_mask:0xf bank_mask:0x4
  v_mov_b32_dpp v80, v92 quad_perm:[0,1,2,3] row_mask:0xf bank_mask:0x8
  v_mov_b32_dpp v81, v93 quad_perm:[0,1,2,3] row_mask:0xf bank_mask:0x8
  v_mov_b32_dpp v82, v94 quad_perm:[0,1,2,3] row_mask:0xf bank_mask:0x8
  v_mov_b32_dpp v83, v95 quad_perm:[0,1,2,3] row_mask:0xf bank_mask:0x8
  v_bfi_b32 v80, v18, s68, v80
  v_bfi_b32 v81, v18, s69, v81
  v_bfi_b32 v82, v18, s70, v82
  v_bfi_b32 v83, v18, s71, v83
  s_lshl_b32 s66, s4, 15
  s_lshl_b32 s67, s6, 11
  s_add_u32 s66, s66, s67
  s_xor_b32 s67, s5, 4
  s_lshl_b32 s67, s67, 8
  s_add_u32 s66, s66, s67
  v_lshlrev_b32 v28, 13, v10
  v_lshl_add_u32 v28, v9, 6, v28
  v_lshl_add_u32 v28, v8, 4, v28
  buffer_store_dwordx4 v[80:83], v28, s[44:47], s66 offen offset:0 sc1
  buffer_load_dwordx4 v[144:147], v3, s[36:39], s53 offen offset:0 nt
  buffer_load_dwordx4 v[148:151], v3, s[36:39], s53 offen offset:1024 nt
  buffer_load_dwordx4 v[152:155], v3, s[36:39], s53 offen offset:2048 nt
  buffer_load_dwordx4 v[156:159], v3, s[36:39], s53 offen offset:3072 nt
  buffer_load_dwordx4 v[160:163], v3, s[36:39], s54 offen offset:0 nt
  buffer_load_dwordx4 v[164:167], v3, s[36:39], s54 offen offset:1024 nt
  buffer_load_dwordx4 v[168:171], v3, s[36:39], s54 offen offset:2048 nt
  buffer_load_dwordx4 v[172:175], v3, s[36:39], s54 offen offset:3072 nt
  buffer_load_dwordx4 v[176:179], v3, s[36:39], s55 offen offset:0 nt
  buffer_load_dwordx4 v[180:183], v3, s[36:39], s55 offen offset:1024 nt
  buffer_load_dwordx4 v[184:187], v3, s[36:39], s55 offen offset:2048 nt
  buffer_load_dwordx4 v[188:191], v3, s[36:39], s55 offen offset:3072 nt
  buffer_load_dwordx4 v[192:195], v3, s[36:39], s56 offen offset:0 nt
  buffer_load_dwordx4 v[196:199], v3, s[36:39], s56 offen offset:1024 nt
  buffer_load_dwordx4 v[200:203], v3, s[36:39], s56 offen offset:2048 nt
  buffer_load_dwordx4 v[204:207], v3, s[36:39], s56 offen offset:3072 nt
  buffer_load_dwordx4 v[208:211], v3, s[36:39], s57 offen offset:0 nt
  buffer_load_dwordx4 v[212:215], v3, s[36:39], s57 offen offset:1024 nt
  buffer_load_dwordx4 v[216:219], v3, s[36:39], s57 offen offset:2048 nt
  buffer_load_dwordx4 v[220:223], v3, s[36:39], s57 offen offset:3072 nt
  buffer_load_dwordx4 v[224:227], v3, s[36:39], s58 offen offset:0 nt
  buffer_load_dwordx4 v[228:231], v3, s[36:39], s58 offen offset:1024 nt
  buffer_load_dwordx4 v[232:235], v3, s[36:39], s58 offen offset:2048 nt
  buffer_load_dwordx4 v[236:239], v3, s[36:39], s58 offen offset:3072 nt
  buffer_load_dwordx4 v[240:243], v2, s[40:43], 0 offen offset:0 nt
  buffer_load_dwordx4 v[244:247], v2, s[40:43], 0 offen offset:1024 nt
  buffer_load_dwordx4 v[248:251], v2, s[40:43], 0 offen offset:2048 nt
  buffer_load_dwordx4 v[252:255], v2, s[40:43], 0 offen offset:3072 nt
  s_lshl_b32 s66, s4, 19
  s_lshl_b32 s67, s3, 16
  s_add_u32 s66, s66, s67
  s_xor_b32 s67, s5, 4
  s_lshl_b32 s67, s67, 7
  s_add_u32 s66, s66, s67
  s_add_u32 s16, s16, s66
  s_addc_u32 s17, s17, 0
  s_mov_b32 s18, 0x400000
  s_sub_u32 s18, s18, s66
  s_mov_b32 s19, 0x20000
  s_cmp_eq_u32 s5, 7
  s_cselect_b32 s75, 1, s5
  s_add_u32 s75, s75, s4
  s_add_u32 s75, s75, 6
  s_sub_u32 s66, s75, 7
  s_cmp_ge_u32 s75, 7
  s_cselect_b32 s75, s66, s75
  s_sub_u32 s66, s75, 7
  s_cmp_ge_u32 s75, 7
  s_cselect_b32 s75, s66, s75
  s_mul_i32 s66, s4, 7
  s_add_u32 s75, s75, s66
  s_mul_i32 s66, s3, 229376
  s_lshl_b32 s67, s75, 6
  s_add_u32 s66, s66, s67
  s_add_u32 s48, s20, s66
  s_addc_u32 s49, s21, 0
  s_sub_u32 s50, 1835008, s66
  s_mov_b32 s51, 0x20000
  s_lshl_b32 s66, s75, 15
  s_lshl_b32 s67, s3, 7
  s_add_u32 s66, s66, s67
  s_add_u32 s60, s24, s66
  s_addc_u32 s61, s25, 0
  s_sub_u32 s62, 1835008, s66
  s_mov_b32 s63, 0x20000
  s_cmp_eq_u32 s5, 7
  s_cselect_b32 s50, 0, s50
  s_cselect_b32 s62, 0, s62
  s_lshl_b32 s34, s3, 14
  v_and_b32 v14, 7, v1
  v_lshlrev_b32 v15, 1, v8
  v_xor_b32 v14, v14, v15
  v_lshlrev_b32 v14, 4, v14
  v_lshrrev_b32 v13, 3, v1
  v_lshl_add_u32 v13, v13, 10, v14
  v_bfe_u32 v11, v1, 3, 2
  v_lshlrev_b32 v11, 2, v11
  v_lshrrev_b32 v12, 5, v1
  v_add_u32 v11, v11, v12
  v_lshl_add_u32 v11, v11, 10, v14
  v_lshl_add_u32 v12, v8, 4, v9
  v_mul_u32_u24 v12, 3584, v12
  v_and_b32 v15, 2, v15
  v_xor_b32 v14, v10, v15
  v_lshl_add_u32 v12, v14, 4, v12
  s_lshl_b32 s66, s4, 15
  s_lshl_b32 s67, s6, 13
  s_add_u32 s66, s66, s67
  s_add_u32 s66, s66, 0
  s_add_u32 s67, s66, 4096
  s_mov_b32 s74, 0
L_pq:
  buffer_load_dwordx4 v[48:51], v2, s[44:47], s66 offen offset:0 sc1
  buffer_load_dwordx4 v[52:55], v2, s[44:47], s66 offen offset:1024 sc1
  buffer_load_dwordx4 v[56:59], v2, s[44:47], s66 offen offset:2048 sc1
  buffer_load_dwordx4 v[60:63], v2, s[44:47], s66 offen offset:3072 sc1
  buffer_load_dwordx4 v[64:67], v2, s[44:47], s67 offen offset:0 sc1
  buffer_load_dwordx4 v[68:71], v2, s[44:47], s67 offen offset:1024 sc1
  buffer_load_dwordx4 v[72:75], v2, s[44:47], s67 offen offset:2048 sc1
  buffer_load_dwordx4 v[76:79], v2, s[44:47], s67 offen offset:3072 sc1
  s_waitcnt vmcnt(0)
  v_xor_b32 v48, s68, v48
  v_xor_b32 v49, s69, v49
  v_xor_b32 v50, s70, v50
  v_xor_b32 v51, s71, v51
  v_xor_b32 v52, s68, v52
  v_xor_b32 v53, s69, v53
  v_xor_b32 v54, s70, v54
  v_xor_b32 v55, s71, v55
  v_xor_b32 v56, s68, v56
  v_xor_b32 v57, s69, v57
  v_xor_b32 v58, s70, v58
  v_xor_b32 v59, s71, v59
  v_xor_b32 v60, s68, v60
  v_xor_b32 v61, s69, v61
  v_xor_b32 v62, s70, v62
  v_xor_b32 v63, s71, v63
  v_xor_b32 v64, s68, v64
  v_xor_b32 v65, s69, v65
  v_xor_b32 v66, s70, v66
  v_xor_b32 v67, s71, v67
  v_xor_b32 v68, s68, v68
  v_xor_b32 v69, s69, v69
  v_xor_b32 v70, s70, v70
  v_xor_b32 v71, s71, v71
  v_xor_b32 v72, s68, v72
  v_xor_b32 v73, s69, v73
  v_xor_b32 v74, s70, v74
  v_xor_b32 v75, s71, v75
  v_xor_b32 v76, s68, v76
  v_xor_b32 v77, s69, v77
  v_xor_b32 v78, s70, v78
  v_xor_b32 v79, s71, v79
  v_or3_b32 v29, v48, v49, v50
  v_or3_b32 v29, v29, v51, v52
  v_or3_b32 v29, v29, v53, v54
  v_or3_b32 v29, v29, v55, v56
  v_or3_b32 v29, v29, v57, v58
  v_or3_b32 v29, v29, v59, v60
  v_or3_b32 v29, v29, v61, v62
  v_or3_b32 v29, v29, v63, v64
  v_or3_b32 v29, v29, v65, v66
  v_or3_b32 v29, v29, v67, v68
  v_or3_b32 v29, v29, v69, v70
  v_or3_b32 v29, v29, v71, v72
  v_or3_b32 v29, v29, v73, v74
  v_or3_b32 v29, v29, v75, v76
  v_or3_b32 v29, v29, v77, v78
  v_or_b32 v29, v29, v79
  v_and_b32 v29, 0xff, v29
  v_cmp_ne_u32 vcc, 0, v29
  s_and_b64 exec, exec, vcc
  s_cbranch_scc0 L_pq_x
  s_add_u32 s74, s74, 1
  s_cmp_lt_u32 s74, 1000000
  s_cbranch_scc1 L_pq
L_pq_x:
  s_mov_b64 exec, -1
  v_add_f32 v48, v48, v56
  v_add_f32 v64, v64, v72
  v_add_f32 v49, v49, v57
  v_add_f32 v65, v65, v73
  v_add_f32 v50, v50, v58
  v_add_f32 v66, v66, v74
  v_add_f32 v51, v51, v59
  v_add_f32 v67, v67, v75
  v_add_f32 v52, v52, v60
  v_add_f32 v68, v68, v76
  v_add_f32 v53, v53, v61
  v_add_f32 v69, v69, v77
  v_add_f32 v54, v54, v62
  v_add_f32 v70, v70, v78
  v_add_f32 v55, v55, v63
  v_add_f32 v71, v71, v79
  v_add_f32 v48, v48, v64
  v_add_f32 v49, v49, v65
  v_add_f32 v50, v50, v66
  v_add_f32 v51, v51, v67
  v_add_f32 v52, v52, v68
  v_add_f32 v53, v53, v69
  v_add_f32 v54, v54, v70
  v_add_f32 v55, v55, v71
  v_cvt_pk_bf16_f32 v4, v48, v49
  v_cvt_pk_bf16_f32 v5, v50, v51
  v_cvt_pk_bf16_f32 v6, v52, v53
  v_cvt_pk_bf16_f32 v7, v54, v55
  v_mov_b32 v29, s64
  v_mov_b32 v28, 17920
  v_lshlrev_b32 v30, 3, v1
  ds_write_b64 v30, v[4:5] offset:16896
  ds_write_b64 v30, v[6:7] offset:17408
  ds_write_b32 v28, v29
  s_waitcnt lgkmcnt(0)
  s_setprio 0
  s_lshl_b32 s66, s6, 10
  s_lshl_b32 s67, s3, 7
  s_add_u32 s66, s66, s67
  v_lshl_add_u32 v23, v1, 1, s66
  global_load_ushort v20, v23, s[8:9]
  s_lshl_b32 s66, s75, 6
  v_bfe_u32 v23, v1, 2, 1
  v_lshlrev_b32 v23, 2, v23
  v_add_u32 v23, v23, v8
  v_lshl_add_u32 v23, v23, 2, v10
  v_lshl_add_u32 v23, v23, 1, s66
  global_load_ushort v21, v23, s[22:23]
  s_lshl_b32 s66, s4, 6
  s_lshl_b32 s67, s5, 3
  s_add_u32 s66, s66, s67
  v_and_b32 v23, 7, v1
  v_bfe_u32 v19, v1, 3, 2
  v_lshl_add_u32 v23, v19, 4, v23
  v_add_u32 v19, s66, v23
  v_and_b32 v19, 511, v19
  v_lshlrev_b32 v23, 1, v19
  global_load_ushort v22, v23, s[26:27]
  s_add_u32 m0, s34, 26112
  s_mov_b32 s67, 0
  buffer_load_dwordx4 v11, s[16:19], s67 offen  lds
  s_add_u32 m0, s34, 34304
  s_mov_b32 s67, 0
  buffer_load_dwordx4 v12, s[48:51], s67 offen  lds
  s_add_u32 m0, s34, 27136
  s_mov_b32 s67, 2048
  buffer_load_dwordx4 v11, s[16:19], s67 offen  lds
  s_add_u32 m0, s34, 28160
  s_mov_b32 s67, 16384
  buffer_load_dwordx4 v11, s[16:19], s67 offen  lds
  s_add_u32 m0, s34, 35328
  s_mov_b32 s67, 14336
  buffer_load_dwordx4 v12, s[48:51], s67 offen  lds
  s_add_u32 m0, s34, 29184
  s_mov_b32 s67, 18432
  buffer_load_dwordx4 v11, s[16:19], s67 offen  lds
  s_add_u32 m0, s34, 30208
  s_mov_b32 s67, 32768
  buffer_load_dwordx4 v11, s[16:19], s67 offen  lds
L_b1:
  s_barrier
  v_mov_b32 v28, 17920
  ds_read_b128 v[4:7], v3 offset:16896
  ds_read_b32 v29, v28
  s_waitcnt lgkmcnt(0)
  v_readfirstlane_b32 s64, v29
  s_mul_i32 s65, s64, 0x9E3779B1
  s_and_b32 s68, s64, 0xfff
  s_lshr_b32 s69, s64, 12
  s_and_b32 s69, s69, 0xfff
  s_lshr_b32 s70, s64, 24
  s_lshl_b32 s66, s65, 8
  s_or_b32 s70, s70, s66
  s_and_b32 s70, s70, 0xfff
  s_lshr_b32 s71, s65, 20
  s_waitcnt vmcnt(4)
  v_mfma_f32_16x16x32_bf16 v[80:83], v[112:115], v[4:7], 0
  v_mfma_f32_16x16x32_bf16 v[84:87], v[116:119], v[4:7], 0
  v_mfma_f32_16x16x32_bf16 v[88:91], v[120:123], v[4:7], 0
  v_mfma_f32_16x16x32_bf16 v[92:95], v[124:127], v[4:7], 0
  v_mfma_f32_16x16x32_bf16 v[96:99], v[128:131], v[4:7], 0
  v_mfma_f32_16x16x32_bf16 v[100:103], v[132:135], v[4:7], 0
  v_mfma_f32_16x16x32_bf16 v[104:107], v[136:139], v[4:7], 0
  v_mfma_f32_16x16x32_bf16 v[108:111], v[140:143], v[4:7], 0
  s_nop 0
  v_mov_b32_dpp v48, v80 quad_perm:[0,0,0,0] row_mask:0xf bank_mask:0xf
  v_mov_b32_dpp v49, v84 quad_perm:[0,0,0,0] row_mask:0xf bank_mask:0xf
  v_mov_b32_dpp v50, v88 quad_perm:[0,0,0,0] row_mask:0xf bank_mask:0xf
  v_mov_b32_dpp v51, v92 quad_perm:[0,0,0,0] row_mask:0xf bank_mask:0xf
  v_add_f32_dpp v48, v81, v48 quad_perm:[1,1,1,1] row_mask:0xf bank_mask:0xf
  v_add_f32_dpp v49, v85, v49 quad_perm:[1,1,1,1] row_mask:0xf bank_mask:0xf
  v_add_f32_dpp v50, v89, v50 quad_perm:[1,1,1,1] row_mask:0xf bank_mask:0xf
  v_add_f32_dpp v51, v93, v51 quad_perm:[1,1,1,1] row_mask:0xf bank_mask:0xf
  v_add_f32_dpp v48, v82, v48 quad_perm:[2,2,2,2] row_mask:0xf bank_mask:0xf
  v_add_f32_dpp v49, v86, v49 quad_perm:[2,2,2,2] row_mask:0xf bank_mask:0xf
  v_add_f32_dpp v50, v90, v50 quad_perm:[2,2,2,2] row_mask:0xf bank_mask:0xf
  v_add_f32_dpp v51, v94, v51 quad_perm:[2,2,2,2] row_mask:0xf bank_mask:0xf
  v_add_f32_dpp v48, v83, v48 quad_perm:[3,3,3,3] row_mask:0xf bank_mask:0xf
  v_add_f32_dpp v49, v87, v49 quad_perm:[3,3,3,3] row_mask:0xf bank_mask:0xf
  v_add_f32_dpp v50, v91, v50 quad_perm:[3,3,3,3] row_mask:0xf bank_mask:0xf
  v_add_f32_dpp v51, v95, v51 quad_perm:[3,3,3,3] row_mask:0xf bank_mask:0xf
  v_mfma_f32_16x16x32_bf16 v[80:83], v[144:147], v[4:7], 0
  v_mfma_f32_16x16x32_bf16 v[84:87], v[148:151], v[4:7], 0
  v_mfma_f32_16x16x32_bf16 v[88:91], v[152:155], v[4:7], 0
  v_mfma_f32_16x16x32_bf16 v[92:95], v[156:159], v[4:7], 0
  s_waitcnt vmcnt(6)
  buffer_load_dwordx4 v[112:115], v2, s[40:43], s52 offen offset:0 nt
  s_add_u32 m0, s34, 36352
  s_mov_b32 s67, 28672
  buffer_load_dwordx4 v12, s[48:51], s67 offen  lds
  v_mov_b32_dpp v52, v96 quad_perm:[0,0,0,0] row_mask:0xf bank_mask:0xf
  v_mov_b32_dpp v53, v100 quad_perm:[0,0,0,0] row_mask:0xf bank_mask:0xf
  v_mov_b32_dpp v54, v104 quad_perm:[0,0,0,0] row_mask:0xf bank_mask:0xf
  v_mov_b32_dpp v55, v108 quad_perm:[0,0,0,0] row_mask:0xf bank_mask:0xf
  v_add_f32_dpp v52, v97, v52 quad_perm:[1,1,1,1] row_mask:0xf bank_mask:0xf
  v_add_f32_dpp v53, v101, v53 quad_perm:[1,1,1,1] row_mask:0xf bank_mask:0xf
  v_add_f32_dpp v54, v105, v54 quad_perm:[1,1,1,1] row_mask:0xf bank_mask:0xf
  v_add_f32_dpp v55, v109, v55 quad_perm:[1,1,1,1] row_mask:0xf bank_mask:0xf
  v_add_f32_dpp v52, v98, v52 quad_perm:[2,2,2,2] row_mask:0xf bank_mask:0xf
  v_add_f32_dpp v53, v102, v53 quad_perm:[2,2,2,2] row_mask:0xf bank_mask:0xf
  v_add_f32_dpp v54, v106, v54 quad_perm:[2,2,2,2] row_mask:0xf bank_mask:0xf
  v_add_f32_dpp v55, v110, v55 quad_perm:[2,2,2,2] row_mask:0xf bank_mask:0xf
  v_add_f32_dpp v52, v99, v52 quad_perm:[3,3,3,3] row_mask:0xf bank_mask:0xf
  v_add_f32_dpp v53, v103, v53 quad_perm:[3,3,3,3] row_mask:0xf bank_mask:0xf
  v_add_f32_dpp v54, v107, v54 quad_perm:[3,3,3,3] row_mask:0xf bank_mask:0xf
  v_add_f32_dpp v55, v111, v55 quad_perm:[3,3,3,3] row_mask:0xf bank_mask:0xf
  v_mfma_f32_16x16x32_bf16 v[96:99], v[160:163], v[4:7], 0
  v_mfma_f32_16x16x32_bf16 v[100:103], v[164:167], v[4:7], 0
  v_mfma_f32_16x16x32_bf16 v[104:107], v[168:171], v[4:7], 0
  v_mfma_f32_16x16x32_bf16 v[108:111], v[172:175], v[4:7], 0
  s_waitcnt vmcnt(6)
  buffer_load_dwordx4 v[116:119], v2, s[40:43], s52 offen offset:1024 nt
  s_add_u32 m0, s34, 31232
  s_mov_b32 s67, 34816
  buffer_load_dwordx4 v11, s[16:19], s67 offen  lds
  v_mov_b32_dpp v56, v80 quad_perm:[0,0,0,0] row_mask:0xf bank_mask:0xf
  v_mov_b32_dpp v57, v84 quad_perm:[0,0,0,0] row_mask:0xf bank_mask:0xf
  v_mov_b32_dpp v58, v88 quad_perm:[0,0,0,0] row_mask:0xf bank_mask:0xf
  v_mov_b32_dpp v59, v92 quad_perm:[0,0,0,0] row_mask:0xf bank_mask:0xf
  v_add_f32_dpp v56, v81, v56 quad_perm:[1,1,1,1] row_mask:0xf bank_mask:0xf
  v_add_f32_dpp v57, v85, v57 quad_perm:[1,1,1,1] row_mask:0xf bank_mask:0xf
  v_add_f32_dpp v58, v89, v58 quad_perm:[1,1,1,1] row_mask:0xf bank_mask:0xf
  v_add_f32_dpp v59, v93, v59 quad_perm:[1,1,1,1] row_mask:0xf bank_mask:0xf
  v_add_f32_dpp v56, v82, v56 quad_perm:[2,2,2,2] row_mask:0xf bank_mask:0xf
  v_add_f32_dpp v57, v86, v57 quad_perm:[2,2,2,2] row_mask:0xf bank_mask:0xf
  v_add_f32_dpp v58, v90, v58 quad_perm:[2,2,2,2] row_mask:0xf bank_mask:0xf
  v_add_f32_dpp v59, v94, v59 quad_perm:[2,2,2,2] row_mask:0xf bank_mask:0xf
  v_add_f32_dpp v56, v83, v56 quad_perm:[3,3,3,3] row_mask:0xf bank_mask:0xf
  v_add_f32_dpp v57, v87, v57 quad_perm:[3,3,3,3] row_mask:0xf bank_mask:0xf
  v_add_f32_dpp v58, v91, v58 quad_perm:[3,3,3,3] row_mask:0xf bank_mask:0xf
  v_add_f32_dpp v59, v95, v59 quad_perm:[3,3,3,3] row_mask:0xf bank_mask:0xf
  v_mfma_f32_16x16x32_bf16 v[80:83], v[176:179], v[4:7], 0
  v_mfma_f32_16x16x32_bf16 v[84:87], v[180:183], v[4:7], 0
  v_mfma_f32_16x16x32_bf16 v[88:91], v[184:187], v[4:7], 0
  v_mfma_f32_16x16x32_bf16 v[92:95], v[188:191], v[4:7], 0
  s_waitcnt vmcnt(7)
  buffer_load_dwordx4 v[120:123], v2, s[40:43], s52 offen offset:2048 nt
  s_add_u32 m0, s34, 32256
  s_mov_b32 s67, 49152
  buffer_load_dwordx4 v11, s[16:19], s67 offen  lds
  v_mov_b32_dpp v60, v96 quad_perm:[0,0,0,0] row_mask:0xf bank_mask:0xf
  v_mov_b32_dpp v61, v100 quad_perm:[0,0,0,0] row_mask:0xf bank_mask:0xf
  v_mov_b32_dpp v62, v104 quad_perm:[0,0,0,0] row_mask:0xf bank_mask:0xf
  v_mov_b32_dpp v63, v108 quad_perm:[0,0,0,0] row_mask:0xf bank_mask:0xf
  v_add_f32_dpp v60, v97, v60 quad_perm:[1,1,1,1] row_mask:0xf bank_mask:0xf
  v_add_f32_dpp v61, v101, v61 quad_perm:[1,1,1,1] row_mask:0xf bank_mask:0xf
  v_add_f32_dpp v62, v105, v62 quad_perm:[1,1,1,1] row_mask:0xf bank_mask:0xf
  v_add_f32_dpp v63, v109, v63 quad_perm:[1,1,1,1] row_mask:0xf bank_mask:0xf
  v_add_f32_dpp v60, v98, v60 quad_perm:[2,2,2,2] row_mask:0xf bank_mask:0xf
  v_add_f32_dpp v61, v102, v61 quad_perm:[2,2,2,2] row_mask:0xf bank_mask:0xf
  v_add_f32_dpp v62, v106, v62 quad_perm:[2,2,2,2] row_mask:0xf bank_mask:0xf
  v_add_f32_dpp v63, v110, v63 quad_perm:[2,2,2,2] row_mask:0xf bank_mask:0xf
  v_add_f32_dpp v60, v99, v60 quad_perm:[3,3,3,3] row_mask:0xf bank_mask:0xf
  v_add_f32_dpp v61, v103, v61 quad_perm:[3,3,3,3] row_mask:0xf bank_mask:0xf
  v_add_f32_dpp v62, v107, v62 quad_perm:[3,3,3,3] row_mask:0xf bank_mask:0xf
  v_add_f32_dpp v63, v111, v63 quad_perm:[3,3,3,3] row_mask:0xf bank_mask:0xf
  v_mfma_f32_16x16x32_bf16 v[96:99], v[192:195], v[4:7], 0
  v_mfma_f32_16x16x32_bf16 v[100:103], v[196:199], v[4:7], 0
  v_mfma_f32_16x16x32_bf16 v[104:107], v[200:203], v[4:7], 0
  v_mfma_f32_16x16x32_bf16 v[108:111], v[204:207], v[4:7], 0
  s_waitcnt vmcnt(8)
  buffer_load_dwordx4 v[124:127], v2, s[40:43], s52 offen offset:3072 nt
  s_add_u32 m0, s34, 37376
  s_mov_b32 s67, 43008
  buffer_load_dwordx4 v12, s[48:51], s67 offen  lds
  v_mov_b32_dpp v64, v80 quad_perm:[0,0,0,0] row_mask:0xf bank_mask:0xf
  v_mov_b32_dpp v65, v84 quad_perm:[0,0,0,0] row_mask:0xf bank_mask:0xf
  v_mov_b32_dpp v66, v88 quad_perm:[0,0,0,0] row_mask:0xf bank_mask:0xf
  v_mov_b32_dpp v67, v92 quad_perm:[0,0,0,0] row_mask:0xf bank_mask:0xf
  v_add_f32_dpp v64, v81, v64 quad_perm:[1,1,1,1] row_mask:0xf bank_mask:0xf
  v_add_f32_dpp v65, v85, v65 quad_perm:[1,1,1,1] row_mask:0xf bank_mask:0xf
  v_add_f32_dpp v66, v89, v66 quad_perm:[1,1,1,1] row_mask:0xf bank_mask:0xf
  v_add_f32_dpp v67, v93, v67 quad_perm:[1,1,1,1] row_mask:0xf bank_mask:0xf
  v_add_f32_dpp v64, v82, v64 quad_perm:[2,2,2,2] row_mask:0xf bank_mask:0xf
  v_add_f32_dpp v65, v86, v65 quad_perm:[2,2,2,2] row_mask:0xf bank_mask:0xf
  v_add_f32_dpp v66, v90, v66 quad_perm:[2,2,2,2] row_mask:0xf bank_mask:0xf
  v_add_f32_dpp v67, v94, v67 quad_perm:[2,2,2,2] row_mask:0xf bank_mask:0xf
  v_add_f32_dpp v64, v83, v64 quad_perm:[3,3,3,3] row_mask:0xf bank_mask:0xf
  v_add_f32_dpp v65, v87, v65 quad_perm:[3,3,3,3] row_mask:0xf bank_mask:0xf
  v_add_f32_dpp v66, v91, v66 quad_perm:[3,3,3,3] row_mask:0xf bank_mask:0xf
  v_add_f32_dpp v67, v95, v67 quad_perm:[3,3,3,3] row_mask:0xf bank_mask:0xf
  v_mfma_f32_16x16x32_bf16 v[80:83], v[208:211], v[4:7], 0
  v_mfma_f32_16x16x32_bf16 v[84:87], v[212:215], v[4:7], 0
  v_mfma_f32_16x16x32_bf16 v[88:91], v[216:219], v[4:7], 0
  v_mfma_f32_16x16x32_bf16 v[92:95], v[220:223], v[4:7], 0
  s_waitcnt vmcnt(9)
  buffer_load_dwordx4 v[128:131], v2, s[40:43], s53 offen offset:0 nt
  s_add_u32 m0, s34, 33280
  s_mov_b32 s67, 51200
  buffer_load_dwordx4 v11, s[16:19], s67 offen  lds
  v_mov_b32_dpp v68, v96 quad_perm:[0,0,0,0] row_mask:0xf bank_mask:0xf
  v_mov_b32_dpp v69, v100 quad_perm:[0,0,0,0] row_mask:0xf bank_mask:0xf
  v_mov_b32_dpp v70, v104 quad_perm:[0,0,0,0] row_mask:0xf bank_mask:0xf
  v_mov_b32_dpp v71, v108 quad_perm:[0,0,0,0] row_mask:0xf bank_mask:0xf
  v_add_f32_dpp v68, v97, v68 quad_perm:[1,1,1,1] row_mask:0xf bank_mask:0xf
  v_add_f32_dpp v69, v101, v69 quad_perm:[1,1,1,1] row_mask:0xf bank_mask:0xf
  v_add_f32_dpp v70, v105, v70 quad_perm:[1,1,1,1] row_mask:0xf bank_mask:0xf
  v_add_f32_dpp v71, v109, v71 quad_perm:[1,1,1,1] row_mask:0xf bank_mask:0xf
  v_add_f32_dpp v68, v98, v68 quad_perm:[2,2,2,2] row_mask:0xf bank_mask:0xf
  v_add_f32_dpp v69, v102, v69 quad_perm:[2,2,2,2] row_mask:0xf bank_mask:0xf
  v_add_f32_dpp v70, v106, v70 quad_perm:[2,2,2,2] row_mask:0xf bank_mask:0xf
  v_add_f32_dpp v71, v110, v71 quad_perm:[2,2,2,2] row_mask:0xf bank_mask:0xf
  v_add_f32_dpp v68, v99, v68 quad_perm:[3,3,3,3] row_mask:0xf bank_mask:0xf
  v_add_f32_dpp v69, v103, v69 quad_perm:[3,3,3,3] row_mask:0xf bank_mask:0xf
  v_add_f32_dpp v70, v107, v70 quad_perm:[3,3,3,3] row_mask:0xf bank_mask:0xf
  v_add_f32_dpp v71, v111, v71 quad_perm:[3,3,3,3] row_mask:0xf bank_mask:0xf
  v_mfma_f32_16x16x32_bf16 v[96:99], v[224:227], v[4:7], 0
  v_mfma_f32_16x16x32_bf16 v[100:103], v[228:231], v[4:7], 0
  v_mfma_f32_16x16x32_bf16 v[104:107], v[232:235], v[4:7], 0
  v_mfma_f32_16x16x32_bf16 v[108:111], v[236:239], v[4:7], 0
  s_waitcnt vmcnt(10)
  buffer_load_dwordx4 v[132:135], v2, s[40:43], s53 offen offset:1024 nt
  v_mov_b32_dpp v72, v80 quad_perm:[0,0,0,0] row_mask:0xf bank_mask:0xf
  v_mov_b32_dpp v73, v84 quad_perm:[0,0,0,0] row_mask:0xf bank_mask:0xf
  v_mov_b32_dpp v74, v88 quad_perm:[0,0,0,0] row_mask:0xf bank_mask:0xf
  v_mov_b32_dpp v75, v92 quad_perm:[0,0,0,0] row_mask:0xf bank_mask:0xf
  v_add_f32_dpp v72, v81, v72 quad_perm:[1,1,1,1] row_mask:0xf bank_mask:0xf
  v_add_f32_dpp v73, v85, v73 quad_perm:[1,1,1,1] row_mask:0xf bank_mask:0xf
  v_add_f32_dpp v74, v89, v74 quad_perm:[1,1,1,1] row_mask:0xf bank_mask:0xf
  v_add_f32_dpp v75, v93, v75 quad_perm:[1,1,1,1] row_mask:0xf bank_mask:0xf
  v_add_f32_dpp v72, v82, v72 quad_perm:[2,2,2,2] row_mask:0xf bank_mask:0xf
  v_add_f32_dpp v73, v86, v73 quad_perm:[2,2,2,2] row_mask:0xf bank_mask:0xf
  v_add_f32_dpp v74, v90, v74 quad_perm:[2,2,2,2] row_mask:0xf bank_mask:0xf
  v_add_f32_dpp v75, v94, v75 quad_perm:[2,2,2,2] row_mask:0xf bank_mask:0xf
  v_add_f32_dpp v72, v83, v72 quad_perm:[3,3,3,3] row_mask:0xf bank_mask:0xf
  v_add_f32_dpp v73, v87, v73 quad_perm:[3,3,3,3] row_mask:0xf bank_mask:0xf
  v_add_f32_dpp v74, v91, v74 quad_perm:[3,3,3,3] row_mask:0xf bank_mask:0xf
  v_add_f32_dpp v75, v95, v75 quad_perm:[3,3,3,3] row_mask:0xf bank_mask:0xf
  s_waitcnt vmcnt(10)
  buffer_load_dwordx4 v[136:139], v2, s[40:43], s53 offen offset:2048 nt
  v_mov_b32_dpp v76, v96 quad_perm:[0,0,0,0] row_mask:0xf bank_mask:0xf
  v_mov_b32_dpp v77, v100 quad_perm:[0,0,0,0] row_mask:0xf bank_mask:0xf
  v_mov_b32_dpp v78, v104 quad_perm:[0,0,0,0] row_mask:0xf bank_mask:0xf
  v_mov_b32_dpp v79, v108 quad_perm:[0,0,0,0] row_mask:0xf bank_mask:0xf
  v_add_f32_dpp v76, v97, v76 quad_perm:[1,1,1,1] row_mask:0xf bank_mask:0xf
  v_add_f32_dpp v77, v101, v77 quad_perm:[1,1,1,1] row_mask:0xf bank_mask:0xf
  v_add_f32_dpp v78, v105, v78 quad_perm:[1,1,1,1] row_mask:0xf bank_mask:0xf
  v_add_f32_dpp v79, v109, v79 quad_perm:[1,1,1,1] row_mask:0xf bank_mask:0xf
  v_add_f32_dpp v76, v98, v76 quad_perm:[2,2,2,2] row_mask:0xf bank_mask:0xf
  v_add_f32_dpp v77, v102, v77 quad_perm:[2,2,2,2] row_mask:0xf bank_mask:0xf
  v_add_f32_dpp v78, v106, v78 quad_perm:[2,2,2,2] row_mask:0xf bank_mask:0xf
  v_add_f32_dpp v79, v110, v79 quad_perm:[2,2,2,2] row_mask:0xf bank_mask:0xf
  v_add_f32_dpp v76, v99, v76 quad_perm:[3,3,3,3] row_mask:0xf bank_mask:0xf
  v_add_f32_dpp v77, v103, v77 quad_perm:[3,3,3,3] row_mask:0xf bank_mask:0xf
  v_add_f32_dpp v78, v107, v78 quad_perm:[3,3,3,3] row_mask:0xf bank_mask:0xf
  v_add_f32_dpp v79, v111, v79 quad_perm:[3,3,3,3] row_mask:0xf bank_mask:0xf
  s_mov_b32 s66, 1035273459
  v_cvt_pk_bf16_f32 v24, v48, v49
  v_lshlrev_b32 v48, 16, v24
  v_and_b32 v49, 0xffff0000, v24
  v_mul_f32 v48, s66, v48
  v_mul_f32 v49, s66, v49
  v_cvt_pk_bf16_f32 v24, v48, v49
  v_lshlrev_b32 v48, 16, v24
  v_and_b32 v49, 0xffff0000, v24
  v_max_f32 v25, v48, v49
  v_cvt_pk_bf16_f32 v24, v50, v51
  v_lshlrev_b32 v50, 16, v24
  v_and_b32 v51, 0xffff0000, v24
  v_mul_f32 v50, s66, v50
  v_mul_f32 v51, s66, v51
  v_cvt_pk_bf16_f32 v24, v50, v51
  v_lshlrev_b32 v50, 16, v24
  v_and_b32 v51, 0xffff0000, v24
  v_max3_f32 v25, v25, v50, v51
  v_cvt_pk_bf16_f32 v24, v52, v53
  v_lshlrev_b32 v52, 16, v24
  v_and_b32 v53, 0xffff0000, v24
  v_mul_f32 v52, s66, v52
  v_mul_f32 v53, s66, v53
  v_cvt_pk_bf16_f32 v24, v52, v53
  v_lshlrev_b32 v52, 16, v24
  v_and_b32 v53, 0xffff0000, v24
  v_max3_f32 v25, v25, v52, v53
  v_cvt_pk_bf16_f32 v24, v54, v55
  v_lshlrev_b32 v54, 16, v24
  v_and_b32 v55, 0xffff0000, v24
  v_mul_f32 v54, s66, v54
  v_mul_f32 v55, s66, v55
  v_cvt_pk_bf16_f32 v24, v54, v55
  v_lshlrev_b32 v54, 16, v24
  v_and_b32 v55, 0xffff0000, v24
  v_max3_f32 v25, v25, v54, v55
  v_cvt_pk_bf16_f32 v24, v56, v57
  v_lshlrev_b32 v56, 16, v24
  v_and_b32 v57, 0xffff0000, v24
  v_mul_f32 v56, s66, v56
  v_mul_f32 v57, s66, v57
  v_cvt_pk_bf16_f32 v24, v56, v57
  v_lshlrev_b32 v56, 16, v24
  v_and_b32 v57, 0xffff0000, v24
  v_max3_f32 v25, v25, v56, v57
  s_waitcnt vmcnt(9)
  buffer_load_dwordx4 v[140:143], v2, s[40:43], s53 offen offset:3072 nt
  s_mov_b32 s66, 1035273459
  v_cvt_pk_bf16_f32 v24, v58, v59
  v_lshlrev_b32 v58, 16, v24
  v_and_b32 v59, 0xffff0000, v24
  v_mul_f32 v58, s66, v58
  v_mul_f32 v59, s66, v59
  v_cvt_pk_bf16_f32 v24, v58, v59
  v_lshlrev_b32 v58, 16, v24
  v_and_b32 v59, 0xffff0000, v24
  v_max3_f32 v25, v25, v58, v59
  v_cvt_pk_bf16_f32 v24, v60, v61
  v_lshlrev_b32 v60, 16, v24
  v_and_b32 v61, 0xffff0000, v24
  v_mul_f32 v60, s66, v60
  v_mul_f32 v61, s66, v61
  v_cvt_pk_bf16_f32 v24, v60, v61
  v_lshlrev_b32 v60, 16, v24
  v_and_b32 v61, 0xffff0000, v24
  v_max3_f32 v25, v25, v60, v61
  v_cvt_pk_bf16_f32 v24, v62, v63
  v_lshlrev_b32 v62, 16, v24
  v_and_b32 v63, 0xffff0000, v24
  v_mul_f32 v62, s66, v62
  v_mul_f32 v63, s66, v63
  v_cvt_pk_bf16_f32 v24, v62, v63
  v_lshlrev_b32 v62, 16, v24
  v_and_b32 v63, 0xffff0000, v24
  v_max3_f32 v25, v25, v62, v63
  v_cvt_pk_bf16_f32 v24, v64, v65
  v_lshlrev_b32 v64, 16, v24
  v_and_b32 v65, 0xffff0000, v24
  v_mul_f32 v64, s66, v64
  v_mul_f32 v65, s66, v65
  v_cvt_pk_bf16_f32 v24, v64, v65
  v_lshlrev_b32 v64, 16, v24
  v_and_b32 v65, 0xffff0000, v24
  v_max3_f32 v25, v25, v64, v65
  v_cvt_pk_bf16_f32 v24, v66, v67
  v_lshlrev_b32 v66, 16, v24
  v_and_b32 v67, 0xffff0000, v24
  v_mul_f32 v66, s66, v66
  v_mul_f32 v67, s66, v67
  v_cvt_pk_bf16_f32 v24, v66, v67
  v_lshlrev_b32 v66, 16, v24
  v_and_b32 v67, 0xffff0000, v24
  v_max3_f32 v25, v25, v66, v67
  v_cvt_pk_bf16_f32 v24, v68, v69
  v_lshlrev_b32 v68, 16, v24
  v_and_b32 v69, 0xffff0000, v24
  v_mul_f32 v68, s66, v68
  v_mul_f32 v69, s66, v69
  v_cvt_pk_bf16_f32 v24, v68, v69
  v_lshlrev_b32 v68, 16, v24
  v_and_b32 v69, 0xffff0000, v24
  v_max3_f32 v25, v25, v68, v69
  s_waitcnt vmcnt(8)
  buffer_load_dwordx4 v[144:147], v2, s[40:43], s54 offen offset:0 nt
  s_mov_b32 s66, 1035273459
  v_cvt_pk_bf16_f32 v24, v70, v71
  v_lshlrev_b32 v70, 16, v24
  v_and_b32 v71, 0xffff0000, v24
  v_mul_f32 v70, s66, v70
  v_mul_f32 v71, s66, v71
  v_cvt_pk_bf16_f32 v24, v70, v71
  v_lshlrev_b32 v70, 16, v24
  v_and_b32 v71, 0xffff0000, v24
  v_max3_f32 v25, v25, v70, v71
  v_cvt_pk_bf16_f32 v24, v72, v73
  v_lshlrev_b32 v72, 16, v24
  v_and_b32 v73, 0xffff0000, v24
  v_mul_f32 v72, s66, v72
  v_mul_f32 v73, s66, v73
  v_cvt_pk_bf16_f32 v24, v72, v73
  v_lshlrev_b32 v72, 16, v24
  v_and_b32 v73, 0xffff0000, v24
  v_max3_f32 v25, v25, v72, v73
  v_cvt_pk_bf16_f32 v24, v74, v75
  v_lshlrev_b32 v74, 16, v24
  v_and_b32 v75, 0xffff0000, v24
  v_mul_f32 v74, s66, v74
  v_mul_f32 v75, s66, v75
  v_cvt_pk_bf16_f32 v24, v74, v75
  v_lshlrev_b32 v74, 16, v24
  v_and_b32 v75, 0xffff0000, v24
  v_max3_f32 v25, v25, v74, v75
  v_cvt_pk_bf16_f32 v24, v76, v77
  v_lshlrev_b32 v76, 16, v24
  v_and_b32 v77, 0xffff0000, v24
  v_mul_f32 v76, s66, v76
  v_mul_f32 v77, s66, v77
  v_cvt_pk_bf16_f32 v24, v76, v77
  v_lshlrev_b32 v76, 16, v24
  v_and_b32 v77, 0xffff0000, v24
  v_max3_f32 v25, v25, v76, v77
  v_cvt_pk_bf16_f32 v24, v78, v79
  v_lshlrev_b32 v78, 16, v24
  v_and_b32 v79, 0xffff0000, v24
  v_mul_f32 v78, s66, v78
  v_mul_f32 v79, s66, v79
  v_cvt_pk_bf16_f32 v24, v78, v79
  v_lshlrev_b32 v78, 16, v24
  v_and_b32 v79, 0xffff0000, v24
  v_max3_f32 v25, v25, v78, v79
  v_mov_b32 v24, v25
  s_nop 1
  v_permlane16_swap_b32 v24, v25
  v_max_f32 v25, v24, v25
  v_mov_b32 v24, v25
  s_nop 1
  v_permlane32_swap_b32 v24, v25
  v_max_f32 v25, v24, v25
  s_lshl_b32 s66, s3, 2
  v_lshlrev_b32 v26, 5, v9
  v_add_u32 v27, s66, v26
  ds_write_b32 v27, v25 offset:17984
  s_waitcnt lgkmcnt(0)
  s_barrier
  ds_read_b128 v[28:31], v26 offset:17984
  ds_read_b128 v[32:35], v26 offset:18000
  s_waitcnt vmcnt(7)
  buffer_load_dwordx4 v[148:151], v2, s[40:43], s54 offen offset:1024 nt
  s_waitcnt lgkmcnt(0)
  v_max3_f32 v25, v28, v29, v30
  v_max3_f32 v25, v25, v31, v32
  v_max3_f32 v25, v25, v33, v34
  v_max_f32 v25, v25, v35
  s_mov_b32 s66, 1069066811
  v_mul_f32 v24, s66, v25
  v_fma_f32 v48, v48, s66, -v24
  v_fma_f32 v49, v49, s66, -v24
  v_fma_f32 v50, v50, s66, -v24
  v_fma_f32 v51, v51, s66, -v24
  v_fma_f32 v52, v52, s66, -v24
  v_fma_f32 v53, v53, s66, -v24
  v_fma_f32 v54, v54, s66, -v24
  v_fma_f32 v55, v55, s66, -v24
  v_fma_f32 v56, v56, s66, -v24
  v_fma_f32 v57, v57, s66, -v24
  v_fma_f32 v58, v58, s66, -v24
  v_fma_f32 v59, v59, s66, -v24
  v_fma_f32 v60, v60, s66, -v24
  v_fma_f32 v61, v61, s66, -v24
  v_fma_f32 v62, v62, s66, -v24
  v_fma_f32 v63, v63, s66, -v24
  v_fma_f32 v64, v64, s66, -v24
  v_fma_f32 v65, v65, s66, -v24
  v_fma_f32 v66, v66, s66, -v24
  v_fma_f32 v67, v67, s66, -v24
  v_fma_f32 v68, v68, s66, -v24
  v_fma_f32 v69, v69, s66, -v24
  v_fma_f32 v70, v70, s66, -v24
  v_fma_f32 v71, v71, s66, -v24
  v_fma_f32 v72, v72, s66, -v24
  v_fma_f32 v73, v73, s66, -v24
  v_fma_f32 v74, v74, s66, -v24
  v_fma_f32 v75, v75, s66, -v24
  v_fma_f32 v76, v76, s66, -v24
  v_fma_f32 v77, v77, s66, -v24
  v_fma_f32 v78, v78, s66, -v24
  v_fma_f32 v79, v79, s66, -v24
  s_waitcnt vmcnt(6)
  buffer_load_dwordx4 v[152:155], v2, s[40:43], s54 offen offset:2048 nt
  v_exp_f32 v48, v48
  v_exp_f32 v49, v49
  v_exp_f32 v50, v50
  v_exp_f32 v51, v51
  v_exp_f32 v52, v52
  v_exp_f32 v53, v53
  v_exp_f32 v54, v54
  v_exp_f32 v55, v55
  v_exp_f32 v56, v56
  v_exp_f32 v57, v57
  v_exp_f32 v58, v58
  v_exp_f32 v59, v59
  v_exp_f32 v60, v60
  v_exp_f32 v61, v61
  v_exp_f32 v62, v62
  v_exp_f32 v63, v63
  v_exp_f32 v64, v64
  v_exp_f32 v65, v65
  v_exp_f32 v66, v66
  v_exp_f32 v67, v67
  v_exp_f32 v68, v68
  v_exp_f32 v69, v69
  v_exp_f32 v70, v70
  v_exp_f32 v71, v71
  v_exp_f32 v72, v72
  v_exp_f32 v73, v73
  v_exp_f32 v74, v74
  v_exp_f32 v75, v75
  v_exp_f32 v76, v76
  v_exp_f32 v77, v77
  v_exp_f32 v78, v78
  v_exp_f32 v79, v79
  s_waitcnt vmcnt(5)
  buffer_load_dwordx4 v[156:159], v2, s[40:43], s54 offen offset:3072 nt
  v_add_f32 v28, v48, v49
  v_add_f32 v29, v50, v51
  v_add_f32 v28, v28, v52
  v_add_f32 v29, v29, v53
  v_add_f32 v28, v28, v54
  v_add_f32 v29, v29, v55
  v_add_f32 v28, v28, v56
  v_add_f32 v29, v29, v57
  v_add_f32 v28, v28, v58
  v_add_f32 v29, v29, v59
  v_add_f32 v28, v28, v60
  v_add_f32 v29, v29, v61
  v_add_f32 v28, v28, v62
  v_add_f32 v29, v29, v63
  v_add_f32 v28, v28, v64
  v_add_f32 v29, v29, v65
  v_add_f32 v28, v28, v66
  v_add_f32 v29, v29, v67
  v_add_f32 v28, v28, v68
  v_add_f32 v29, v29, v69
  v_add_f32 v28, v28, v70
  v_add_f32 v29, v29, v71
  v_add_f32 v28, v28, v72
  v_add_f32 v29, v29, v73
  v_add_f32 v28, v28, v74
  v_add_f32 v29, v29, v75
  v_add_f32 v28, v28, v76
  v_add_f32 v29, v29, v77
  v_add_f32 v28, v28, v78
  v_add_f32 v29, v29, v79
  v_add_f32 v28, v28, v29
  v_cvt_pk_bf16_f32 v48, v48, v49
  v_cvt_pk_bf16_f32 v49, v50, v51
  v_cvt_pk_bf16_f32 v50, v52, v53
  v_cvt_pk_bf16_f32 v51, v54, v55
  v_cvt_pk_bf16_f32 v52, v56, v57
  v_cvt_pk_bf16_f32 v53, v58, v59
  v_cvt_pk_bf16_f32 v54, v60, v61
  v_cvt_pk_bf16_f32 v55, v62, v63
  v_cvt_pk_bf16_f32 v56, v64, v65
  v_cvt_pk_bf16_f32 v57, v66, v67
  v_cvt_pk_bf16_f32 v58, v68, v69
  v_cvt_pk_bf16_f32 v59, v70, v71
  v_cvt_pk_bf16_f32 v60, v72, v73
  v_cvt_pk_bf16_f32 v61, v74, v75
  v_cvt_pk_bf16_f32 v62, v76, v77
  v_cvt_pk_bf16_f32 v63, v78, v79
  v_mov_b32 v29, v28
  s_nop 1
  v_permlane16_swap_b32 v29, v28
  v_add_f32 v28, v29, v28
  v_mov_b32 v29, v28
  s_nop 1
  v_permlane32_swap_b32 v29, v28
  v_add_f32 v28, v29, v28
  ds_write_b32 v27, v28 offset:18112
  s_waitcnt lgkmcnt(0)
  s_barrier
  v_mov_b32 v18, 0xfff
  s_getreg_b32 s35, hwreg(HW_REG_XCC_ID, 0, 4)
  s_lshl_b32 s35, s35, 12
  s_cmp_lg_u32 s3, 0
  s_cbranch_scc1 L_nostat
  ds_read_b128 v[28:31], v26 offset:18112
  ds_read_b128 v[32:35], v26 offset:18128
  s_lshl_b32 s66, s2, 7
  s_add_u32 s66, s66, 262144
  s_or_b32 s67, s35, s70
  v_lshlrev_b32 v24, 4, v9
  s_waitcnt lgkmcnt(0)
  v_add_f32 v28, v28, v29
  v_add_f32 v30, v30, v31
  v_add_f32 v32, v32, v33
  v_add_f32 v34, v34, v35
  v_add_f32 v28, v28, v30
  v_add_f32 v32, v32, v34
  v_add_f32 v28, v28, v32
  v_bfi_b32 v32, v18, s68, v25
  v_bfi_b32 v33, v18, s69, v28
  v_mov_b32 v34, s67
  v_mov_b32 v35, s71
  s_mov_b64 exec, 0x1111
  buffer_store_dwordx4 v[32:35], v24, s[44:47], s66 offen sc1
  s_mov_b64 exec, -1
  s_branch L_stat
L_nostat:
  s_mov_b64 exec, 1
  buffer_load_dword v40, v2, s[44:47], 0 offen offset:0
  s_mov_b64 exec, -1
L_stat:
  s_waitcnt vmcnt(4)
  buffer_load_dwordx4 v[160:163], v2, s[40:43], s55 offen offset:0 nt
  v_perm_b32 v64, v244, v240, s72
  v_perm_b32 v68, v244, v240, s73
  v_perm_b32 v65, v252, v248, s72
  v_perm_b32 v69, v252, v248, s73
  v_perm_b32 v66, v116, v112, s72
  v_perm_b32 v70, v116, v112, s73
  v_perm_b32 v67, v124, v120, s72
  v_perm_b32 v71, v124, v120, s73
  s_nop 0
  v_mfma_f32_16x16x32_bf16 v[80:83], v[48:51], v[64:67], 0
  v_mfma_f32_16x16x32_bf16 v[84:87], v[48:51], v[68:71], 0
  v_perm_b32 v72, v245, v241, s72
  v_perm_b32 v76, v245, v241, s73
  v_perm_b32 v73, v253, v249, s72
  v_perm_b32 v77, v253, v249, s73
  v_perm_b32 v74, v117, v113, s72
  v_perm_b32 v78, v117, v113, s73
  v_perm_b32 v75, v125, v121, s72
  v_perm_b32 v79, v125, v121, s73
  s_nop 0
  v_mfma_f32_16x16x32_bf16 v[88:91], v[48:51], v[72:75], 0
  v_mfma_f32_16x16x32_bf16 v[92:95], v[48:51], v[76:79], 0
  v_perm_b32 v64, v246, v242, s72
  v_perm_b32 v68, v246, v242, s73
  v_perm_b32 v65, v254, v250, s72
  v_perm_b32 v69, v254, v250, s73
  v_perm_b32 v66, v118, v114, s72
  v_perm_b32 v70, v118, v114, s73
  v_perm_b32 v67, v126, v122, s72
  v_perm_b32 v71, v126, v122, s73
  s_nop 0
  v_mfma_f32_16x16x32_bf16 v[96:99], v[48:51], v[64:67], 0
  v_mfma_f32_16x16x32_bf16 v[100:103], v[48:51], v[68:71], 0
  v_perm_b32 v72, v247, v243, s72
  v_perm_b32 v76, v247, v243, s73
  v_perm_b32 v73, v255, v251, s72
  v_perm_b32 v77, v255, v251, s73
  v_perm_b32 v74, v119, v115, s72
  v_perm_b32 v78, v119, v115, s73
  v_perm_b32 v75, v127, v123, s72
  v_perm_b32 v79, v127, v123, s73
  s_nop 0
  v_mfma_f32_16x16x32_bf16 v[104:107], v[48:51], v[72:75], 0
  v_mfma_f32_16x16x32_bf16 v[108:111], v[48:51], v[76:79], 0
  s_waitcnt vmcnt(4)
  buffer_load_dwordx4 v[164:167], v2, s[40:43], s55 offen offset:1024 nt
  v_lshrrev_b32 v23, 2, v1
  v_and_b32 v14, 1, v23
  v_lshlrev_b32 v14, 10, v14
  v_lshrrev_b32 v15, 1, v23
  v_lshl_add_u32 v14, v15, 4, v14
  v_mul_u32_u24 v15, 2112, v10
  s_lshl_b32 s66, s3, 7
  v_add3_u32 v14, v14, v15, s66
  s_mul_i32 s66, s3, 2112
  v_add_u32 v15, s66, v2
  s_lshl_b32 s66, s2, 11
  s_lshl_b32 s67, s3, 8
  s_add_u32 s66, s66, s67
  s_add_u32 s66, s66, 327680
  v_lshl_add_u32 v16, v23, 4, s66
  v_lshrrev_b32 v31, 3, v1
  v_lshlrev_b32 v17, 14, v31
  v_and_b32 v34, 7, v1
  v_lshl_add_u32 v17, v34, 4, v17
  v_lshlrev_b32 v31, 11, v31
  v_lshl_add_u32 v31, v34, 4, v31
  s_lshl_b32 s66, s6, 17
  s_add_u32 s66, s66, s67
  s_lshl_b32 s67, s4, 11
  s_add_u32 s66, s66, s67
  s_add_u32 s66, s66, 327680
  v_add_u32 v17, s66, v17
  s_lshl_b32 s66, s6, 14
  s_lshl_b32 s67, s3, 8
  s_add_u32 s66, s66, s67
  s_add_u32 s66, s66, 851968
  v_add_u32 v31, s66, v31
  v_mul_u32_u24 v34, 320, v10
  v_lshl_add_u32 v34, v23, 4, v34
  v_lshlrev_b32 v35, 4, v23
  s_waitcnt vmcnt(4)
  buffer_load_dwordx4 v[168:171], v2, s[40:43], s55 offen offset:2048 nt
  v_and_b32 v45, 15, v1
  v_lshlrev_b32 v45, 4, v45
  s_lshl_b32 s66, s2, 11
  s_lshl_b32 s67, s3, 8
  s_add_u32 s66, s66, s67
  s_add_u32 s66, s66, 327680
  buffer_load_dword v40, v45, s[44:47], s66 offen
  s_mul_i32 s14, s6, 114688
  s_lshl_b32 s66, s75, 11
  s_add_u32 s14, s14, s66
  s_add_u32 s14, s14, s67
  s_add_u32 s14, s14, 1048576
  buffer_load_dword v40, v45, s[44:47], s14 offen
  s_lshl_b32 s15, s6, 14
  s_lshl_b32 s67, s4, 11
  s_add_u32 s15, s15, s67
  s_xor_b32 s67, s5, 4
  s_lshl_b32 s67, s67, 8
  s_add_u32 s15, s15, s67
  s_add_u32 s15, s15, 851968
  buffer_load_dword v40, v45, s[44:47], s15 offen
  v_lshl_add_u32 v29, v8, 2, v9
  v_lshlrev_b32 v24, 7, v29
  v_lshlrev_b32 v28, 6, v29
  v_bfe_u32 v29, v29, 1, 2
  v_lshl_add_u32 v24, v29, 5, v24
  v_lshl_add_u32 v24, v10, 3, v24
  v_add_u32 v24, s34, v24
  v_xor_b32 v25, 32, v24
  v_xor_b32 v26, 64, v24
  v_xor_b32 v27, 0x60, v24
  v_and_b32 v29, 1, v8
  v_lshl_add_u32 v28, v29, 5, v28
  v_lshl_add_u32 v28, v10, 3, v28
  v_add_u32 v28, s34, v28
  v_xor_b32 v29, 32, v28
  ds_read_b64_tr_b16 v[224:225], v28 offset:34304
  ds_read_b64_tr_b16 v[226:227], v28 offset:35328
  ds_read_b64_tr_b16 v[228:229], v29 offset:34304
  ds_read_b64_tr_b16 v[230:231], v29 offset:35328
  ds_read_b64_tr_b16 v[232:233], v28 offset:36352
  ds_read_b64_tr_b16 v[234:235], v28 offset:37376
  ds_read_b64_tr_b16 v[236:237], v29 offset:36352
  ds_read_b64_tr_b16 v[238:239], v29 offset:37376
  v_and_b32 v46, 15, v1
  s_mul_i32 s66, s3, 320
  v_lshl_add_u32 v33, v46, 4, s66
  s_and_b32 s66, s3, 3
  s_lshl_b32 s66, s66, 2
  s_lshr_b32 s67, s3, 2
  s_lshl_b32 s67, s67, 9
  s_add_u32 s66, s66, s67
  v_lshl_add_u32 v46, v46, 4, s66
  v_add_u32 v47, 24064, v46
  v_add_u32 v32, 23040, v46
  v_mov_b32 v4, 0x3f803f80
  v_mov_b32 v5, 0x3f803f80
  v_mov_b32 v6, 0x3f803f80
  v_mov_b32 v7, 0x3f803f80
  s_waitcnt vmcnt(7)
  buffer_load_dwordx4 v[172:175], v2, s[40:43], s55 offen offset:3072 nt
  v_perm_b32 v64, v132, v128, s72
  v_perm_b32 v68, v132, v128, s73
  v_perm_b32 v65, v140, v136, s72
  v_perm_b32 v69, v140, v136, s73
  v_perm_b32 v66, v148, v144, s72
  v_perm_b32 v70, v148, v144, s73
  v_perm_b32 v67, v156, v152, s72
  v_perm_b32 v71, v156, v152, s73
  s_nop 0
  v_mfma_f32_16x16x32_bf16 v[80:83], v[52:55], v[64:67], v[80:83]
  v_mfma_f32_16x16x32_bf16 v[84:87], v[52:55], v[68:71], v[84:87]
  v_perm_b32 v72, v133, v129, s72
  v_perm_b32 v76, v133, v129, s73
  v_perm_b32 v73, v141, v137, s72
  v_perm_b32 v77, v141, v137, s73
  v_perm_b32 v74, v149, v145, s72
  v_perm_b32 v78, v149, v145, s73
  v_perm_b32 v75, v157, v153, s72
  v_perm_b32 v79, v157, v153, s73
  s_nop 0
  v_mfma_f32_16x16x32_bf16 v[88:91], v[52:55], v[72:75], v[88:91]
  v_mfma_f32_16x16x32_bf16 v[92:95], v[52:55], v[76:79], v[92:95]
  v_perm_b32 v64, v134, v130, s72
  v_perm_b32 v68, v134, v130, s73
  v_perm_b32 v65, v142, v138, s72
  v_perm_b32 v69, v142, v138, s73
  v_perm_b32 v66, v150, v146, s72
  v_perm_b32 v70, v150, v146, s73
  v_perm_b32 v67, v158, v154, s72
  v_perm_b32 v71, v158, v154, s73
  s_nop 0
  v_mfma_f32_16x16x32_bf16 v[96:99], v[52:55], v[64:67], v[96:99]
  v_mfma_f32_16x16x32_bf16 v[100:103], v[52:55], v[68:71], v[100:103]
  v_perm_b32 v72, v135, v131, s72
  v_perm_b32 v76, v135, v131, s73
  v_perm_b32 v73, v143, v139, s72
  v_perm_b32 v77, v143, v139, s73
  v_perm_b32 v74, v151, v147, s72
  v_perm_b32 v78, v151, v147, s73
  v_perm_b32 v75, v159, v155, s72
  v_perm_b32 v79, v159, v155, s73
  s_nop 0
  v_mfma_f32_16x16x32_bf16 v[104:107], v[52:55], v[72:75], v[104:107]
  v_mfma_f32_16x16x32_bf16 v[108:111], v[52:55], v[76:79], v[108:111]
  s_waitcnt vmcnt(6)
  buffer_load_dwordx4 v[176:179], v2, s[40:43], s56 offen offset:0 nt
  s_waitcnt lgkmcnt(0)
  ds_read_b64_tr_b16 v[112:113], v24 offset:26112
  ds_read_b64_tr_b16 v[114:115], v24 offset:28160
  ds_read_b64_tr_b16 v[116:117], v25 offset:26112
  ds_read_b64_tr_b16 v[118:119], v25 offset:28160
  ds_read_b64_tr_b16 v[120:121], v26 offset:26112
  ds_read_b64_tr_b16 v[122:123], v26 offset:28160
  ds_read_b64_tr_b16 v[124:125], v27 offset:26112
  ds_read_b64_tr_b16 v[126:127], v27 offset:28160
  v_mfma_f32_16x16x32_bf16 v[144:147], v[4:7], v[224:227], 0
  v_mfma_f32_16x16x32_bf16 v[148:151], v[4:7], v[228:231], 0
  v_mfma_f32_16x16x32_bf16 v[144:147], v[4:7], v[232:235], v[144:147]
  v_mfma_f32_16x16x32_bf16 v[148:151], v[4:7], v[236:239], v[148:151]
  s_waitcnt vmcnt(6)
  buffer_load_dwordx4 v[180:183], v2, s[40:43], s56 offen offset:1024 nt
  s_waitcnt lgkmcnt(0)
  ds_read_b64_tr_b16 v[128:129], v24 offset:30208
  ds_read_b64_tr_b16 v[130:131], v24 offset:32256
  ds_read_b64_tr_b16 v[132:133], v25 offset:30208
  ds_read_b64_tr_b16 v[134:135], v25 offset:32256
  ds_read_b64_tr_b16 v[136:137], v26 offset:30208
  ds_read_b64_tr_b16 v[138:139], v26 offset:32256
  ds_read_b64_tr_b16 v[140:141], v27 offset:30208
  ds_read_b64_tr_b16 v[142:143], v27 offset:32256
  ds_write2_b32 v47, v144, v148 offset0:0 offset1:64
  s_waitcnt vmcnt(6)
  buffer_load_dwordx4 v[184:187], v2, s[40:43], s56 offen offset:2048 nt
  s_waitcnt vmcnt(3)
  buffer_load_dwordx4 v[188:191], v2, s[40:43], s56 offen offset:3072 nt
  v_lshrrev_b32 v44, 3, v1
  s_lshl_b32 s66, s6, 13
  s_lshl_b32 s67, s4, 7
  s_add_u32 s66, s66, s67
  s_lshr_b32 s67, s3, 1
  s_lshl_b32 s67, s67, 4
  s_add_u32 s66, s66, s67
  s_add_u32 s66, s66, 262144
  v_lshl_add_u32 v44, v44, 10, s66
  buffer_load_dwordx4 v[36:39], v44, s[44:47], 0 offen sc1
  s_waitcnt vmcnt(4)
  buffer_load_dwordx4 v[192:195], v2, s[40:43], s57 offen offset:0 nt
  s_waitcnt vmcnt(4)
  buffer_load_dwordx4 v[196:199], v2, s[40:43], s57 offen offset:1024 nt
  s_waitcnt vmcnt(4)
  buffer_load_dwordx4 v[200:203], v2, s[40:43], s57 offen offset:2048 nt
  s_waitcnt vmcnt(4)
  buffer_load_dwordx4 v[204:207], v2, s[40:43], s57 offen offset:3072 nt
  v_perm_b32 v64, v164, v160, s72
  v_perm_b32 v68, v164, v160, s73
  v_perm_b32 v65, v172, v168, s72
  v_perm_b32 v69, v172, v168, s73
  v_perm_b32 v66, v180, v176, s72
  v_perm_b32 v70, v180, v176, s73
  v_perm_b32 v67, v188, v184, s72
  v_perm_b32 v71, v188, v184, s73
  s_nop 0
  v_mfma_f32_16x16x32_bf16 v[80:83], v[56:59], v[64:67], v[80:83]
  v_mfma_f32_16x16x32_bf16 v[84:87], v[56:59], v[68:71], v[84:87]
  v_perm_b32 v72, v165, v161, s72
  v_perm_b32 v76, v165, v161, s73
  v_perm_b32 v73, v173, v169, s72
  v_perm_b32 v77, v173, v169, s73
  v_perm_b32 v74, v181, v177, s72
  v_perm_b32 v78, v181, v177, s73
  v_perm_b32 v75, v189, v185, s72
  v_perm_b32 v79, v189, v185, s73
  s_nop 0
  v_mfma_f32_16x16x32_bf16 v[88:91], v[56:59], v[72:75], v[88:91]
  v_mfma_f32_16x16x32_bf16 v[92:95], v[56:59], v[76:79], v[92:95]
  v_perm_b32 v64, v166, v162, s72
  v_perm_b32 v68, v166, v162, s73
  v_perm_b32 v65, v174, v170, s72
  v_perm_b32 v69, v174, v170, s73
  v_perm_b32 v66, v182, v178, s72
  v_perm_b32 v70, v182, v178, s73
  v_perm_b32 v67, v190, v186, s72
  v_perm_b32 v71, v190, v186, s73
  s_nop 0
  v_mfma_f32_16x16x32_bf16 v[96:99], v[56:59], v[64:67], v[96:99]
  v_mfma_f32_16x16x32_bf16 v[100:103], v[56:59], v[68:71], v[100:103]
  v_perm_b32 v72, v167, v163, s72
  v_perm_b32 v76, v167, v163, s73
  v_perm_b32 v73, v175, v171, s72
  v_perm_b32 v77, v175, v171, s73
  v_perm_b32 v74, v183, v179, s72
  v_perm_b32 v78, v183, v179, s73
  v_perm_b32 v75, v191, v187, s72
  v_perm_b32 v79, v191, v187, s73
  s_nop 0
  v_mfma_f32_16x16x32_bf16 v[104:107], v[56:59], v[72:75], v[104:107]
  v_mfma_f32_16x16x32_bf16 v[108:111], v[56:59], v[76:79], v[108:111]
  s_waitcnt vmcnt(3)
  buffer_load_dwordx4 v[208:211], v2, s[40:43], s58 offen offset:0 nt
  s_mov_b32 s74, 0
  s_waitcnt vmcnt(5)
  s_branch L_ps_c
L_ps:
  buffer_load_dwordx4 v[36:39], v44, s[44:47], 0 offen offset:0 sc1
  s_waitcnt vmcnt(0)
L_ps_c:
  v_xor_b32 v36, s68, v36
  v_xor_b32 v37, s69, v37
  v_xor_b32 v38, s70, v38
  v_xor_b32 v39, s71, v39
  v_or3_b32 v46, v36, v37, v38
  v_or_b32 v46, v46, v39
  v_and_b32 v46, 0xfff, v46
  v_cmp_ne_u32 vcc, 0, v46
  s_and_b64 exec, exec, vcc
  s_cbranch_scc0 L_ps_x
  s_add_u32 s74, s74, 1
  s_cmp_lt_u32 s74, 1000000
  s_cbranch_scc1 L_ps
L_ps_x:
  s_mov_b64 exec, -1
  v_cmp_ne_u32 vcc, s35, v38
  v_max_f32_dpp v45, v36, v36 row_ror:8 row_mask:0xf bank_mask:0xf
  v_mov_b32 v46, v45
  s_cmp_eq_u64 vcc, 0
  s_cselect_b32 s59, 1, 0
  v_permlane16_swap_b32 v46, v45
  v_max_f32 v45, v46, v45
  v_mov_b32 v46, v45
  s_nop 1
  v_permlane32_swap_b32 v46, v45
  v_max_f32 v45, v46, v45
  v_sub_f32 v45, v36, v45
  v_mul_f32 v45, 1069066811, v45
  v_exp_f32 v30, v45
  s_nop 0
  v_mul_f32 v45, v30, v37
  s_nop 1
  v_add_f32_dpp v45, v45, v45 row_ror:8 row_mask:0xf bank_mask:0xf
  v_mov_b32 v46, v45
  s_nop 1
  v_permlane16_swap_b32 v46, v45
  v_add_f32 v45, v46, v45
  v_mov_b32 v46, v45
  s_nop 1
  v_permlane32_swap_b32 v46, v45
  v_add_f32 v45, v46, v45
  v_rcp_f32 v45, v45
  s_nop 0
  v_mul_f32 v30, v30, v45
  s_waitcnt vmcnt(3)
  buffer_load_dwordx4 v[212:215], v2, s[40:43], s58 offen offset:1024 nt
  s_waitcnt vmcnt(3)
  buffer_load_dwordx4 v[216:219], v2, s[40:43], s58 offen offset:2048 nt
  s_waitcnt vmcnt(3)
  buffer_load_dwordx4 v[220:223], v2, s[40:43], s58 offen offset:3072 nt
L_tail:
  s_waitcnt vmcnt(6)
  v_perm_b32 v160, v196, v192, s72
  v_perm_b32 v164, v196, v192, s73
  v_perm_b32 v168, v197, v193, s72
  v_perm_b32 v172, v197, v193, s73
  v_perm_b32 v176, v198, v194, s72
  v_perm_b32 v180, v198, v194, s73
  v_perm_b32 v184, v199, v195, s72
  v_perm_b32 v188, v199, v195, s73
  s_waitcnt vmcnt(4)
  v_perm_b32 v161, v204, v200, s72
  v_perm_b32 v165, v204, v200, s73
  v_perm_b32 v169, v205, v201, s72
  v_perm_b32 v173, v205, v201, s73
  v_perm_b32 v177, v206, v202, s72
  v_perm_b32 v181, v206, v202, s73
  v_perm_b32 v185, v207, v203, s72
  v_perm_b32 v189, v207, v203, s73
  s_waitcnt vmcnt(2)
  v_perm_b32 v162, v212, v208, s72
  v_perm_b32 v166, v212, v208, s73
  v_perm_b32 v170, v213, v209, s72
  v_perm_b32 v174, v213, v209, s73
  v_perm_b32 v178, v214, v210, s72
  v_perm_b32 v182, v214, v210, s73
  v_perm_b32 v186, v215, v211, s72
  v_perm_b32 v190, v215, v211, s73
  s_waitcnt vmcnt(0)
  v_perm_b32 v163, v220, v216, s72
  v_perm_b32 v167, v220, v216, s73
  v_perm_b32 v171, v221, v217, s72
  v_perm_b32 v175, v221, v217, s73
  v_mfma_f32_16x16x32_bf16 v[80:83], v[60:63], v[160:163], v[80:83]
  v_mfma_f32_16x16x32_bf16 v[84:87], v[60:63], v[164:167], v[84:87]
  v_perm_b32 v179, v222, v218, s72
  v_perm_b32 v183, v222, v218, s73
  v_mfma_f32_16x16x32_bf16 v[88:91], v[60:63], v[168:171], v[88:91]
  v_mfma_f32_16x16x32_bf16 v[92:95], v[60:63], v[172:175], v[92:95]
  v_perm_b32 v187, v223, v219, s72
  v_perm_b32 v191, v223, v219, s73
  v_mfma_f32_16x16x32_bf16 v[96:99], v[60:63], v[176:179], v[96:99]
  v_mfma_f32_16x16x32_bf16 v[100:103], v[60:63], v[180:183], v[100:103]
  v_mfma_f32_16x16x32_bf16 v[104:107], v[60:63], v[184:187], v[104:107]
  v_mfma_f32_16x16x32_bf16 v[108:111], v[60:63], v[188:191], v[108:111]
  v_mov_b32 v81, v84
  v_mov_b32 v82, v88
  v_mov_b32 v83, v92
  ds_write_b128 v15, v[80:83] offset:0
  s_nop 1
  v_mov_b32 v97, v100
  v_mov_b32 v98, v104
  v_mov_b32 v99, v108
  ds_write_b128 v15, v[96:99] offset:1024
  s_waitcnt lgkmcnt(0)
  s_barrier
  ds_read_b128 v[36:39], v14 offset:0
  ds_read_b128 v[40:43], v14 offset:8448
  s_waitcnt lgkmcnt(0)
  v_add_f32 v36, v36, v40
  v_add_f32 v37, v37, v41
  v_add_f32 v38, v38, v42
  v_add_f32 v39, v39, v43
  v_add_f32_dpp v36, v36, v36 quad_perm:[1,0,3,2] row_mask:0xf bank_mask:0xf
  v_add_f32_dpp v37, v37, v37 quad_perm:[1,0,3,2] row_mask:0xf bank_mask:0xf
  v_add_f32_dpp v38, v38, v38 quad_perm:[1,0,3,2] row_mask:0xf bank_mask:0xf
  v_add_f32_dpp v39, v39, v39 quad_perm:[1,0,3,2] row_mask:0xf bank_mask:0xf
  v_add_f32_dpp v36, v36, v36 quad_perm:[2,3,0,1] row_mask:0xf bank_mask:0xf
  v_add_f32_dpp v37, v37, v37 quad_perm:[2,3,0,1] row_mask:0xf bank_mask:0xf
  v_add_f32_dpp v38, v38, v38 quad_perm:[2,3,0,1] row_mask:0xf bank_mask:0xf
  v_add_f32_dpp v39, v39, v39 quad_perm:[2,3,0,1] row_mask:0xf bank_mask:0xf
  v_bfi_b32 v36, v18, s68, v36
  v_bfi_b32 v37, v18, s69, v37
  v_bfi_b32 v38, v18, s70, v38
  v_bfi_b32 v39, v18, s71, v39
  s_mov_b32 exec_lo, 0x11111111
  s_mov_b32 exec_hi, 0x11111111
  s_cmp_eq_u32 s59, 0
  s_cbranch_scc1 L_s1_far
  buffer_store_dwordx4 v[36:39], v16, s[44:47], 0 offen
  s_branch L_s1_done
L_s1_far:
  buffer_store_dwordx4 v[36:39], v16, s[44:47], 0 offen sc1
L_s1_done:
  s_mov_b64 exec, -1
  s_mov_b32 s74, 0
L_p1:
  buffer_load_dwordx4 v[36:39], v17, s[44:47], 0 offen offset:0 sc1
  buffer_load_dwordx4 v[40:43], v17, s[44:47], 0 offen offset:128 sc1
  s_waitcnt vmcnt(0)
  v_xor_b32 v36, s68, v36
  v_xor_b32 v37, s69, v37
  v_xor_b32 v38, s70, v38
  v_xor_b32 v39, s71, v39
  v_xor_b32 v40, s68, v40
  v_xor_b32 v41, s69, v41
  v_xor_b32 v42, s70, v42
  v_xor_b32 v43, s71, v43
  v_or3_b32 v44, v36, v37, v38
  v_or3_b32 v44, v44, v39, v40
  v_or3_b32 v44, v44, v41, v42
  v_or_b32 v44, v44, v43
  v_and_b32 v44, 0xfff, v44
  v_cmp_ne_u32 vcc, 0, v44
  s_and_b64 exec, exec, vcc
  s_cbranch_scc0 L_p1_x
  s_add_u32 s74, s74, 1
  s_cmp_lt_u32 s74, 1000000
  s_cbranch_scc1 L_p1
L_p1_x:
  s_mov_b64 exec, -1
  v_mul_f32 v36, v30, v36
  v_mul_f32 v37, v30, v37
  v_mul_f32 v38, v30, v38
  v_mul_f32 v39, v30, v39
  v_mul_f32 v40, v30, v40
  v_mul_f32 v41, v30, v41
  v_mul_f32 v42, v30, v42
  v_mul_f32 v43, v30, v43
  v_add_f32_dpp v48, v36, v36 row_ror:8 row_mask:0xf bank_mask:0x3
  v_add_f32_dpp v49, v37, v37 row_ror:8 row_mask:0xf bank_mask:0x3
  v_add_f32_dpp v50, v38, v38 row_ror:8 row_mask:0xf bank_mask:0x3
  v_add_f32_dpp v51, v39, v39 row_ror:8 row_mask:0xf bank_mask:0x3
  v_add_f32_dpp v48, v40, v40 row_ror:8 row_mask:0xf bank_mask:0xc
  v_add_f32_dpp v49, v41, v41 row_ror:8 row_mask:0xf bank_mask:0xc
  v_add_f32_dpp v50, v42, v42 row_ror:8 row_mask:0xf bank_mask:0xc
  v_add_f32_dpp v51, v43, v43 row_ror:8 row_mask:0xf bank_mask:0xc
  s_nop 0
  v_permlane32_swap_b32 v48, v50
  v_permlane32_swap_b32 v49, v51
  v_add_f32 v48, v48, v50
  v_add_f32 v49, v49, v51
  s_nop 1
  v_permlane16_swap_b32 v48, v49
  v_add_f32 v48, v48, v49
  s_nop 1
  v_mov_b32_dpp v37, v48 quad_perm:[1,0,3,2] row_mask:0xf bank_mask:0xf
  v_cvt_pk_bf16_f32 v36, v48, v37
  s_nop 1
  v_mov_b32_dpp v37, v36 row_ror:14 row_mask:0xf bank_mask:0xf
  v_mov_b32_dpp v38, v36 row_ror:12 row_mask:0xf bank_mask:0xf
  v_mov_b32_dpp v39, v36 row_ror:10 row_mask:0xf bank_mask:0xf
  v_mov_b32_dpp v40, v36 row_ror:8 row_mask:0xf bank_mask:0xf
  v_mov_b32_dpp v41, v36 row_ror:6 row_mask:0xf bank_mask:0xf
  v_mov_b32_dpp v42, v36 row_ror:4 row_mask:0xf bank_mask:0xf
  v_mov_b32_dpp v43, v36 row_ror:2 row_mask:0xf bank_mask:0xf
  v_mfma_f32_16x16x32_bf16 v[48:51], v[36:39], v[112:115], 0
  v_mfma_f32_16x16x32_bf16 v[52:55], v[36:39], v[116:119], 0
  v_mfma_f32_16x16x32_bf16 v[56:59], v[36:39], v[120:123], 0
  v_mfma_f32_16x16x32_bf16 v[60:63], v[36:39], v[124:127], 0
  v_mfma_f32_16x16x32_bf16 v[48:51], v[40:43], v[128:131], v[48:51]
  v_mfma_f32_16x16x32_bf16 v[52:55], v[40:43], v[132:135], v[52:55]
  v_mfma_f32_16x16x32_bf16 v[56:59], v[40:43], v[136:139], v[56:59]
  v_mfma_f32_16x16x32_bf16 v[60:63], v[40:43], v[140:143], v[60:63]
  s_mov_b64 exec, 0xffff
  s_nop 4
  v_mov_b32 v49, v52
  v_mov_b32 v50, v56
  v_mov_b32 v51, v60
  ds_write_b128 v33, v[48:51] offset:18240
  s_mov_b64 exec, -1
  s_waitcnt lgkmcnt(0)
  s_barrier
  s_cmp_lg_u32 s3, 0
  s_cbranch_scc1 L_noh2pub
  ds_read_b128 v[36:39], v34 offset:18240
  ds_read_b128 v[40:43], v34 offset:19520
  s_waitcnt lgkmcnt(0)
  v_add_f32 v36, v36, v40
  v_add_f32 v37, v37, v41
  v_add_f32 v38, v38, v42
  v_add_f32 v39, v39, v43
  v_add_f32_dpp v36, v36, v36 quad_perm:[1,0,3,2] row_mask:0xf bank_mask:0xf
  v_add_f32_dpp v37, v37, v37 quad_perm:[1,0,3,2] row_mask:0xf bank_mask:0xf
  v_add_f32_dpp v38, v38, v38 quad_perm:[1,0,3,2] row_mask:0xf bank_mask:0xf
  v_add_f32_dpp v39, v39, v39 quad_perm:[1,0,3,2] row_mask:0xf bank_mask:0xf
  v_add_f32_dpp v36, v36, v36 quad_perm:[2,3,0,1] row_mask:0xf bank_mask:0xf
  v_add_f32_dpp v37, v37, v37 quad_perm:[2,3,0,1] row_mask:0xf bank_mask:0xf
  v_add_f32_dpp v38, v38, v38 quad_perm:[2,3,0,1] row_mask:0xf bank_mask:0xf
  v_add_f32_dpp v39, v39, v39 quad_perm:[2,3,0,1] row_mask:0xf bank_mask:0xf
  v_bfi_b32 v36, v18, s68, v36
  v_bfi_b32 v37, v18, s69, v37
  v_bfi_b32 v38, v18, s70, v38
  v_bfi_b32 v39, v18, s71, v39
  s_mov_b32 exec_lo, 0x11111111
  s_mov_b32 exec_hi, 0x11111111
  buffer_store_dwordx4 v[36:39], v35, s[44:47], s15 offen sc1
  s_mov_b64 exec, -1
L_noh2pub:
  s_cmp_eq_u32 s5, 7
  s_cbranch_scc1 L_fin
  v_lshlrev_b32 v16, 2, v1
  s_add_u32 m0, s34, 38400
  s_mov_b32 s67, 0
  buffer_load_dwordx4 v13, s[60:63], s67 offen  lds
  s_add_u32 m0, s34, 39424
  s_mov_b32 s67, 8192
  buffer_load_dwordx4 v13, s[60:63], s67 offen  lds
  s_add_u32 m0, s34, 40448
  s_mov_b32 s67, 16384
  buffer_load_dwordx4 v13, s[60:63], s67 offen  lds
  s_add_u32 m0, s34, 41472
  s_mov_b32 s67, 24576
  buffer_load_dwordx4 v13, s[60:63], s67 offen  lds
  s_cmp_gt_u32 s3, 3
  s_cbranch_scc1 L_now2
  v_add_u32 v24, s34, v24
  v_add_u32 v25, s34, v25
  v_add_u32 v26, s34, v26
  v_add_u32 v27, s34, v27
  s_lshl_b32 s66, s3, 8
  s_add_u32 s14, s14, s66
  v_and_b32 v35, 15, v1
  v_lshlrev_b32 v35, 4, v35
  v_lshrrev_b32 v64, 5, v1
  v_lshl_add_u32 v35, v64, 8, v35
  s_waitcnt lgkmcnt(0)
L_now2:
  v_bfe_u32 v33, v1, 2, 1
  v_lshlrev_b32 v33, 2, v33
  v_add_u32 v33, v33, v8
  v_lshl_add_u32 v33, v33, 2, v10
  v_lshlrev_b32 v33, 4, v33
  s_lshl_b32 s66, s3, 8
  v_add_u32 v14, s66, v16
  s_lshl_b32 s66, s3, 2
  v_mov_b32 v15, 64
  v_mov_b32 v17, s66
  v_cmp_eq_u32 vcc, 16, v1
  v_lshlrev_b32 v21, 16, v21
  v_and_b32 v23, 15, v1
  v_cndmask_b32 v15, v15, v17, vcc
  v_add_u32 v17, 32, v17
  v_cmp_eq_u32 vcc, 0, v1
  v_lshlrev_b32 v23, 2, v23
  v_lshl_add_u32 v32, v8, 10, v32
  v_cndmask_b32 v15, v15, v17, vcc
  v_mov_b32 v64, v4
  v_mov_b32 v65, v4
  v_mov_b32 v66, v4
  v_mov_b32 v67, v4
  v_mov_b32 v68, v4
  v_mov_b32 v69, v4
  v_mov_b32 v70, v4
  v_mov_b32 v71, v4
  ds_read_b128 v[48:51], v33 offset:24064
  ds_read_b128 v[52:55], v33 offset:24576
  s_waitcnt lgkmcnt(0)
  v_add_f32 v48, v48, v49
  v_add_f32 v50, v50, v51
  v_add_f32 v52, v52, v53
  v_add_f32 v54, v54, v55
  v_add_f32 v48, v48, v50
  v_add_f32 v52, v52, v54
  v_add_f32 v34, v48, v52
  v_lshlrev_b32 v20, 16, v20
  s_sleep 10
  s_mov_b32 s74, 0
L_p2:
  buffer_load_dwordx4 v[36:39], v31, s[44:47], 0 offen offset:0 sc1
  buffer_load_dwordx4 v[40:43], v31, s[44:47], 0 offen offset:128 sc1
  s_waitcnt vmcnt(0)
  v_xor_b32 v36, s68, v36
  v_xor_b32 v37, s69, v37
  v_xor_b32 v38, s70, v38
  v_xor_b32 v39, s71, v39
  v_xor_b32 v40, s68, v40
  v_xor_b32 v41, s69, v41
  v_xor_b32 v42, s70, v42
  v_xor_b32 v43, s71, v43
  v_or3_b32 v45, v36, v37, v38
  v_or3_b32 v45, v45, v39, v40
  v_or3_b32 v45, v45, v41, v42
  v_or_b32 v45, v45, v43
  v_and_b32 v45, 0xfff, v45
  v_cmp_ne_u32 vcc, 0, v45
  s_and_b64 exec, exec, vcc
  s_cbranch_scc0 L_p2_x
  s_add_u32 s74, s74, 1
  s_cmp_lt_u32 s74, 1000000
  s_cbranch_scc1 L_p2
L_p2_x:
  s_mov_b64 exec, -1
  v_add_f32_dpp v48, v36, v36 row_ror:8 row_mask:0xf bank_mask:0x3
  v_add_f32_dpp v49, v37, v37 row_ror:8 row_mask:0xf bank_mask:0x3
  v_add_f32_dpp v50, v38, v38 row_ror:8 row_mask:0xf bank_mask:0x3
  v_add_f32_dpp v51, v39, v39 row_ror:8 row_mask:0xf bank_mask:0x3
  v_add_f32_dpp v48, v40, v40 row_ror:8 row_mask:0xf bank_mask:0xc
  v_add_f32_dpp v49, v41, v41 row_ror:8 row_mask:0xf bank_mask:0xc
  v_add_f32_dpp v50, v42, v42 row_ror:8 row_mask:0xf bank_mask:0xc
  v_add_f32_dpp v51, v43, v43 row_ror:8 row_mask:0xf bank_mask:0xc
  s_nop 0
  v_permlane32_swap_b32 v48, v50
  v_permlane32_swap_b32 v49, v51
  v_add_f32 v48, v48, v50
  v_add_f32 v49, v49, v51
  s_nop 1
  v_permlane16_swap_b32 v48, v49
  v_add_f32 v48, v48, v49
  v_cvt_pk_bf16_f32 v48, v48, v48
  v_and_b32 v48, 0xffff0000, v48
  v_add_f32 v48, v48, v20
  v_cvt_pk_bf16_f32 v48, v48, v48
  v_and_b32 v36, 0xffff0000, v48
  s_nop 1
  v_mov_b32_dpp v37, v36 quad_perm:[1,0,3,2] row_mask:0xf bank_mask:0xf
  ds_write_b32 v14, v36 offset:20992
  v_perm_b32 v40, v37, v36, s73
  s_nop 1
  v_mov_b32_dpp v64, v40 quad_perm:[0,1,2,3] row_mask:0xf bank_mask:0xd
  v_mov_b32_dpp v65, v40 row_ror:14 row_mask:0xf bank_mask:0xd
  v_mov_b32_dpp v66, v40 row_ror:12 row_mask:0xf bank_mask:0xd
  v_mov_b32_dpp v67, v40 row_ror:10 row_mask:0xf bank_mask:0xd
  v_mov_b32_dpp v68, v40 row_ror:8 row_mask:0xf bank_mask:0xd
  v_mov_b32_dpp v69, v40 row_ror:6 row_mask:0xf bank_mask:0xd
  v_mov_b32_dpp v70, v40 row_ror:4 row_mask:0xf bank_mask:0xd
  v_mov_b32_dpp v71, v40 row_ror:2 row_mask:0xf bank_mask:0xd
  v_mfma_f32_16x16x32_bf16 v[48:51], v[64:67], v[224:227], 0
  v_mfma_f32_16x16x32_bf16 v[52:55], v[64:67], v[228:231], 0
  v_mfma_f32_16x16x32_bf16 v[56:59], v[64:67], v[64:67], 0
  v_mfma_f32_16x16x32_bf16 v[48:51], v[68:71], v[232:235], v[48:51]
  v_mfma_f32_16x16x32_bf16 v[52:55], v[68:71], v[236:239], v[52:55]
  v_mfma_f32_16x16x32_bf16 v[56:59], v[68:71], v[68:71], v[56:59]
  s_mov_b32 exec_lo, 0xffff
  s_mov_b32 exec_hi, 0
  s_nop 4
  ds_write2_b32 v32, v48, v52 offset0:0 offset1:64
  s_mov_b32 exec_lo, -1
  ds_write_b32 v15, v56 offset:20800
  s_mov_b64 exec, -1
  s_waitcnt lgkmcnt(0)
  s_barrier
  s_cmp_gt_u32 s3, 3
  s_cbranch_scc1 L_nof2
  ds_read_b32 v40, v23 offset:20800
  ds_read_b128 v[56:59], v33 offset:23040
  ds_read_b128 v[60:63], v33 offset:23552
  ds_read_b64_tr_b16 v[192:193], v24 offset:38400
  ds_read_b64_tr_b16 v[194:195], v24 offset:40448
  ds_read_b64_tr_b16 v[196:197], v25 offset:38400
  ds_read_b64_tr_b16 v[198:199], v25 offset:40448
  ds_read_b64_tr_b16 v[200:201], v26 offset:38400
  ds_read_b64_tr_b16 v[202:203], v26 offset:40448
  ds_read_b64_tr_b16 v[204:205], v27 offset:38400
  ds_read_b64_tr_b16 v[206:207], v27 offset:40448
  s_waitcnt lgkmcnt(10)
  v_add_f32_dpp v40, v40, v40 quad_perm:[1,0,3,2] row_mask:0xf bank_mask:0xf
  s_nop 1
  v_add_f32_dpp v40, v40, v40 quad_perm:[2,3,0,1] row_mask:0xf bank_mask:0xf
  s_waitcnt lgkmcnt(9)
  v_add_f32 v56, v56, v57
  v_add_f32_dpp v40, v40, v40 row_half_mirror row_mask:0xf bank_mask:0xf
  v_add_f32 v58, v58, v59
  v_mul_f32 v40, 0x3b000000, v40
  s_waitcnt lgkmcnt(8)
  v_add_f32 v60, v60, v61
  s_waitcnt lgkmcnt(7)
  ds_read_b64_tr_b16 v[208:209], v24 offset:54784
  ds_read_b64_tr_b16 v[210:211], v24 offset:56832
  ds_read_b64_tr_b16 v[212:213], v25 offset:54784
  ds_read_b64_tr_b16 v[214:215], v25 offset:56832
  ds_read_b64_tr_b16 v[216:217], v26 offset:54784
  ds_read_b64_tr_b16 v[218:219], v26 offset:56832
  ds_read_b64_tr_b16 v[220:221], v27 offset:54784
  ds_read_b64_tr_b16 v[222:223], v27 offset:56832
  v_mov_b32 v48, v40
  v_add_f32 v62, v62, v63
  v_add_f32 v56, v56, v58
  v_mov_b32_dpp v48, v40 row_ror:8 row_mask:0xf bank_mask:0x3
  v_mov_b32_dpp v40, v40 row_ror:8 row_mask:0xf bank_mask:0xc
  v_add_f32 v60, v60, v62
  v_fma_f32 v48, -v40, v40, v48
  v_add_f32 v56, v56, v60
  v_max_f32 v48, 0, v48
  v_cvt_pk_bf16_f32 v41, v40, v48
  v_lshlrev_b32 v40, 16, v41
  v_and_b32 v41, 0xffff0000, v41
  v_add_f32 v41, 0x3727c5ac, v41
  v_cvt_pk_bf16_f32 v41, v41, v41
  v_and_b32 v41, 0xffff0000, v41
  v_sqrt_f32 v41, v41
  v_fma_f32 v56, -v40, v34, v56
  v_cvt_pk_bf16_f32 v41, v41, v41
  v_and_b32 v41, 0xffff0000, v41
  v_rcp_f32 v41, v41
  s_nop 0
  v_mul_f32 v40, v56, v41
  v_cvt_pk_bf16_f32 v40, v40, v40
  v_and_b32 v40, 0xffff0000, v40
  v_add_f32 v40, v40, v21
  v_cvt_pk_bf16_f32 v40, v40, v40
  v_and_b32 v40, 0xffff0000, v40
  v_max_f32 v40, 0, v40
  v_mul_f32 v40, v40, v40
  s_nop 1
  v_mov_b32_dpp v45, v40 quad_perm:[1,0,3,2] row_mask:0xf bank_mask:0xf
  v_cvt_pk_bf16_f32 v44, v40, v45
  s_nop 1
  v_mov_b32_dpp v45, v44 row_ror:14 row_mask:0xf bank_mask:0xf
  v_mov_b32_dpp v46, v44 row_ror:12 row_mask:0xf bank_mask:0xf
  v_mov_b32_dpp v47, v44 row_ror:10 row_mask:0xf bank_mask:0xf
  s_waitcnt lgkmcnt(0)
  s_nop 0
  v_mfma_f32_16x16x32_bf16 v[48:51], v[44:47], v[192:195], 0
  v_mfma_f32_16x16x32_bf16 v[52:55], v[44:47], v[196:199], 0
  v_mfma_f32_16x16x32_bf16 v[56:59], v[44:47], v[200:203], 0
  v_mfma_f32_16x16x32_bf16 v[60:63], v[44:47], v[204:207], 0
  v_mfma_f32_16x16x32_bf16 v[64:67], v[44:47], v[208:211], 0
  v_mfma_f32_16x16x32_bf16 v[68:71], v[44:47], v[212:215], 0
  v_mfma_f32_16x16x32_bf16 v[72:75], v[44:47], v[216:219], 0
  v_mfma_f32_16x16x32_bf16 v[76:79], v[44:47], v[220:223], 0
  s_mov_b64 exec, 0xffff
  v_bfi_b32 v40, v18, s68, v48
  v_bfi_b32 v41, v18, s69, v52
  v_bfi_b32 v42, v18, s70, v56
  v_bfi_b32 v43, v18, s71, v60
  s_mov_b32 exec_lo, 0
  s_mov_b32 exec_hi, 0xffff
  v_bfi_b32 v40, v18, s68, v64
  v_bfi_b32 v41, v18, s69, v68
  v_bfi_b32 v42, v18, s70, v72
  v_bfi_b32 v43, v18, s71, v76
  s_mov_b32 exec_lo, 0xffff
  buffer_store_dwordx4 v[40:43], v35, s[44:47], s14 offen sc1
  s_mov_b64 exec, -1
L_nof2:
  s_cmp_gt_u32 s5, 1
  s_cbranch_scc1 L_fin
  v_lshlrev_b32 v22, 16, v22
  v_and_b32 v32, 31, v1
  v_lshlrev_b32 v32, 5, v32
  v_lshrrev_b32 v30, 3, v0
  v_lshlrev_b32 v30, 11, v30
  v_and_b32 v31, 7, v1
  v_lshl_add_u32 v30, v31, 4, v30
  s_mul_i32 s66, s6, 114688
  s_lshl_b32 s67, s4, 8
  s_add_u32 s66, s66, s67
  s_lshl_b32 s67, s5, 7
  s_add_u32 s66, s66, s67
  s_add_u32 s66, s66, 1048576
  v_lshl_add_u32 v31, v8, 3, v31
  v_lshlrev_b32 v31, 5, v31
  s_lshl_b32 s74, s3, 2
  v_add_u32 v31, s74, v31
  v_lshlrev_b32 v33, 2, v19
  ds_read_b32 v34, v33 offset:20992
  s_cmp_eq_u32 s3, 7
  s_cbranch_scc1 L_b8
  s_cmp_lt_u32 s3, 4
  s_cbranch_scc1 L_d3
  s_sleep 8
L_d3:
  s_sleep 10
  s_mov_b32 s74, 0
L_p3:
  buffer_load_dwordx4 v[36:39], v30, s[44:47], s66 offen offset:0 sc1
  s_waitcnt vmcnt(0)
  v_xor_b32 v36, s68, v36
  v_xor_b32 v37, s69, v37
  v_xor_b32 v38, s70, v38
  v_xor_b32 v39, s71, v39
  v_or3_b32 v35, v36, v37, v38
  v_or_b32 v35, v35, v39
  v_and_b32 v35, 0xfff, v35
  v_cmp_ne_u32 vcc, 0, v35
  s_and_b64 exec, exec, vcc
  s_cbranch_scc0 L_p3_x
  s_add_u32 s74, s74, 1
  s_cmp_lt_u32 s74, 1000000
  s_cbranch_scc1 L_p3
L_p3_x:
  s_mov_b64 exec, -1
  v_add_f32_dpp v36, v36, v36 row_ror:8 row_mask:0xf bank_mask:0xf
  v_add_f32_dpp v37, v37, v37 row_ror:8 row_mask:0xf bank_mask:0xf
  v_add_f32_dpp v38, v38, v38 row_ror:8 row_mask:0xf bank_mask:0xf
  v_add_f32_dpp v39, v39, v39 row_ror:8 row_mask:0xf bank_mask:0xf
  s_nop 0
  v_permlane32_swap_b32 v36, v38
  v_permlane32_swap_b32 v37, v39
  v_add_f32 v36, v36, v38
  v_add_f32 v37, v37, v39
  s_nop 1
  v_permlane16_swap_b32 v36, v37
  v_add_f32 v36, v36, v37
  ds_write_b32 v31, v36 offset:25088
L_b8:
  s_waitcnt lgkmcnt(0)
  s_barrier
  s_cmp_lg_u32 s3, 0
  s_cbranch_scc1 L_fin
  ds_read_b128 v[40:43], v32 offset:25088
  ds_read_b128 v[44:47], v32 offset:25104
  s_lshl_b32 s66, s6, 10
  v_lshl_add_u32 v33, v19, 1, s66
  s_waitcnt lgkmcnt(0)
  v_add_f32 v40, v40, v41
  v_add_f32 v42, v42, v43
  v_add_f32 v44, v44, v45
  v_add_f32 v40, v40, v42
  v_add_f32 v44, v44, v46
  v_add_f32 v40, v40, v44
  v_cvt_pk_bf16_f32 v40, v40, v40
  v_and_b32 v40, 0xffff0000, v40
  v_add_f32 v40, v40, v22
  v_cvt_pk_bf16_f32 v40, v40, v40
  v_and_b32 v40, 0xffff0000, v40
  v_add_f32 v40, v40, v34
  v_cvt_pk_bf16_f32 v40, v40, v40
  s_mov_b32 exec_hi, 0
  global_store_short v33, v40, s[28:29]
  s_mov_b64 exec, -1
L_fin:
L_end:
  s_endpgm
.section .rodata,"a"
.p2align 6
.amdhsa_kernel sequential_preLN__gqa_block_cached__dense_activation_squared_relu__decode_kernel
  .amdhsa_next_free_vgpr 256
  .amdhsa_next_free_sgpr 102
  .amdhsa_accum_offset 256
  .amdhsa_group_segment_fixed_size 0
  .amdhsa_kernarg_size 104
  .amdhsa_user_sgpr_count 2
  .amdhsa_user_sgpr_kernarg_segment_ptr 1
  .amdhsa_system_sgpr_workgroup_id_x 1
  .amdhsa_float_denorm_mode_32 3
.end_amdhsa_kernel
```
